```python
import torch

def _softmax(x, axis=-1):
    return torch.softmax(x, dim=axis)
def _gelu(x):
    return torch.nn.functional.gelu(x, approximate="tanh")
def _silu(x):
    return torch.nn.functional.silu(x)
def _sigmoid(x):
    return torch.sigmoid(x)
def _layernorm(x, axis=-1, eps=1e-5):
    m = x.mean(dim=axis, keepdim=True)
    v = x.var(dim=axis, keepdim=True, unbiased=False)
    return (x - m) / torch.sqrt(v + eps)
def _scatter_add(tgt, idx, src, axis=0):
    return tgt.clone().index_add_(axis, idx, src)
def _segment_sum(src, seg, n):
    out = torch.zeros((n,) + src.shape[1:], dtype=src.dtype)
    return out.index_add_(0, seg, src)
def _pad(x, pw):
    flat = tuple(v for pair in reversed(pw) for v in pair)
    return torch.nn.functional.pad(x, flat)

kernel_name = 'recurrent_scan__sliding_block_cached__dense_activation_relu__decode'

def setup_inputs():

    _w = (lambda a: (lambda t: t.to(torch.bfloat16) if t.is_floating_point() else t)(torch.as_tensor(a)))
    def _A_setup():
        B, Sq, D = 4, 1, 512
        Hq, Hkv, Sk, Dh = 32, 8, 8192, 128
        assert Hq % Hkv == 0, (Hq, Hkv)
        return {
            "x": _w((lambda *s: torch.randn(*s, dtype=torch.bfloat16) * 0.05)(B, Sq, D)),
            "k_cache": _w((lambda *s: torch.randn(*s, dtype=torch.bfloat16) * 1.6)(B, Hkv, Sk, Dh)),
            "v_cache": _w((lambda *s: torch.randn(*s, dtype=torch.bfloat16) * 0.2)(B, Hkv, Sk, Dh)),
            "wq": _w((lambda *s: torch.randn(*s, dtype=torch.bfloat16) * 1.6)(D, Hq * Dh) * (D ** -0.5)),
            "wo": _w((lambda *s: torch.randn(*s, dtype=torch.bfloat16) * 0.2)(Hq * Dh, D) * ((Hq * Dh) ** -0.5)),
        }
    _A_in = _A_setup()

    def _B_setup():
        B, S, D, Dff = 4, 1, 512, 1792
        return {
            "x": _w((lambda *s: torch.randn(*s, dtype=torch.bfloat16) * 0.05)(B, S, D)),
            "w1": _w((lambda *s: torch.randn(*s, dtype=torch.bfloat16) * 0.1)(D, Dff)),
            "w2": _w((lambda *s: torch.randn(*s, dtype=torch.bfloat16) * 0.1)(Dff, D)),
        }
    _B_in = _B_setup()

    return {
        "A_x": _A_in["x"],
        "A_k_cache": _A_in["k_cache"],
        "A_v_cache": _A_in["v_cache"],
        "A_wq": _A_in["wq"],
        "A_wo": _A_in["wo"],
        "B_x": _B_in["x"],
        "B_w1": _B_in["w1"],
        "B_w2": _B_in["w2"],
    }

def reference(A_x, A_k_cache, A_v_cache, A_wq, A_wo, B_x, B_w1, B_w2):
    def _A_ref(x, k_cache, v_cache, wq, wo):
        B, Sq, D = x.shape
        Hq, Dh = 32, 128
        Hkv, Sk = k_cache.shape[1], k_cache.shape[2]
        W = min(4096, max(256, Sk // 4))
        rep = Hq // Hkv
        q = (lambda x, *d: x.permute(*d))((x @ wq).reshape(B, Sq, Hq, Dh), 0, 2, 1, 3)
        k = (lambda x, n, axis: torch.repeat_interleave(x, n, dim=axis))(k_cache[:, :, Sk - W:, :], rep, axis=1)
        v = (lambda x, n, axis: torch.repeat_interleave(x, n, dim=axis))(v_cache[:, :, Sk - W:, :], rep, axis=1)
        scores = torch.einsum("bhqd,bhkd->bhqk", q, k) * (Dh ** -0.5)
        p = _softmax(scores, axis=-1)
        o = torch.einsum("bhqk,bhkd->bhqd", p, v)
        return (lambda x, *d: x.permute(*d))(o, 0, 2, 1, 3).reshape(B, Sq, Hq * Dh) @ wo

    def _B_ref(x, w1, w2):
        h = torch.einsum("bsd,df->bsf", x, w1)
        zero = torch.zeros_like(h)
        h = torch.maximum(h, zero)
        return torch.einsum("bsf,fd->bsd", h, w2)

    x = A_x
    xn = _layernorm(x, axis=-1)
    s = _A_ref(xn, A_k_cache, A_v_cache, A_wq, A_wo)
    g = _silu(_B_ref(xn, B_w1, B_w2))
    return x + s * g
```

```asm
; @launch grid=(256,1,1) block=(640,1,1) lds=131072
.amdgcn_target "amdgcn-amd-amdhsa--gfx950"
.text
.globl recurrent_scan__sliding_block_cached__dense_activation_relu__decode_kernel
.p2align 8
.type recurrent_scan__sliding_block_cached__dense_activation_relu__decode_kernel,@function
recurrent_scan__sliding_block_cached__dense_activation_relu__decode_kernel:
    s_cmp_ge_u32 s2, 256
    s_cbranch_scc1 L_end
    s_load_dwordx16 s[16:31], s[0:1], 0
    s_load_dwordx2 s[34:35], s[0:1], 80
    s_load_dwordx2 s[32:33], s[0:1], 64
    s_getpc_b64 s[48:49]
L_pc:
    v_lshlrev_b32 v3, 7, v0
    v_cmp_gt_u32 vcc, L_end-L_pc, v3
    s_and_saveexec_b64 s[50:51], vcc
    s_cbranch_execz L_nocw
    global_load_dword v15, v3, s[48:49]
L_nocw:
    s_mov_b64 exec, s[50:51]
    v_lshrrev_b32 v3, 6, v0
    v_and_b32 v1, 63, v0
    v_readfirstlane_b32 s3, v3
    s_and_b32 s4, s2, 7
    s_lshr_b32 s5, s2, 3
    s_and_b32 s6, s5, 3
    s_lshr_b32 s7, s5, 2
    s_and_b32 s8, s5, 7
    s_lshr_b32 s9, s5, 3
    s_lshl_b32 s10, s4, 2
    s_add_u32 s10, s10, s9
    s_mov_b32 s56, 262144
    v_mov_b32 v2, 1023
    s_cmp_lt_u32 s3, 2
    s_cbranch_scc1 L_HB
    s_cmp_ge_u32 s3, 6
    s_cbranch_scc1 L_A
    v_mov_b32 v90, 0
    v_lshlrev_b32 v8, 2, v1
    ds_write_b32 v8, v90 offset:62080
    s_lshl_b32 s48, s9, 20
    s_mul_i32 s49, s8, 229376
    s_lshl_b32 s50, s6, 24
    s_lshl_b32 s51, s4, 21
    s_add_u32 s50, s50, s51
    s_add_u32 s50, s50, 0x180000
    s_lshl_b32 s51, s7, 16
    s_add_u32 s50, s50, s51
    s_lshl_b32 s51, s4, 3
    s_add_u32 s51, s51, s8
    s_lshl_b32 s51, s51, 7
    s_add_u32 s48, s48, s51
    s_min_u32 s51, s10, 27
    s_lshl_b32 s52, s51, 7
    s_add_u32 s49, s49, s52
    s_lshl_b32 s51, s51, 16
    s_cmp_lg_u32 s3, 2
    s_waitcnt lgkmcnt(0)
    s_cbranch_scc1 L_notw
    s_load_dword s41, s[22:23], s48
    s_load_dword s42, s[28:29], s49
    s_load_dword s43, s[18:19], s50
L_notw:
    s_barrier
    s_branch L_B
L_A:
    s_setprio 2
    s_sub_u32 s3, s3, 6
    v_lshrrev_b32 v13, 3, v1
    v_and_b32 v14, 7, v1
    v_lshlrev_b32 v14, 4, v14
    v_lshl_add_u32 v8, v13, 13, v14
    v_mul_u32_u24 v9, 3584, v13
    v_add_u32 v9, v9, v14
    s_lshl_b32 s51, s9, 20
    s_lshl_b32 s49, s4, 10
    s_add_u32 s51, s51, s49
    s_lshl_b32 s55, s8, 7
    s_add_u32 s51, s51, s55
    s_lshl_b32 s49, s3, 18
    s_add_u32 s51, s51, s49
    s_lshl_b32 s59, s3, 12
    s_add_u32 m0, s59, 0
    s_lshl_b32 s98, s3, 11
    s_lshl_b32 s53, s3, 14
    s_mov_b32 s46, 4194304
    s_mov_b32 s47, 0x20000
    s_xor_b32 s54, s8, 0
    s_lshl_b32 s54, s54, 2
    s_add_u32 s54, s54, s3
    s_mul_i32 s54, s54, 57344
    s_lshl_b32 s49, s10, 7
    s_add_u32 s54, s54, s49
    s_lshl_b32 s48, s6, 24
    s_lshl_b32 s49, s4, 21
    s_add_u32 s48, s48, s49
    s_lshl_b32 s49, s7, 16
    s_add_u32 s48, s48, s49
    s_add_u32 s48, s48, 0x180000
    s_lshr_b32 s50, s2, 0
    s_mul_i32 s50, s50, 9
    s_add_u32 s50, s50, s3
    s_lshl_b32 s50, s50, 10
    s_and_b32 s50, s50, 0xffff
    s_mov_b32 s38, 0x10000
    s_mov_b32 s39, 0x20000
    s_mov_b32 s42, 0x10000
    s_mov_b32 s43, 0x20000
    v_lshrrev_b32 v3, 4, v1
    v_bfe_u32 v4, v1, 2, 2
    v_and_b32 v5, 3, v1
    v_lshlrev_b32 v7, 4, v1
    v_lshlrev_b32 v6, 4, v5
    v_lshl_add_u32 v6, v3, 6, v6
    v_lshl_add_u32 v6, v4, 8, v6
    s_waitcnt lgkmcnt(0)
    s_mov_b32 s44, s22
    s_mov_b32 s45, s23
    buffer_load_dwordx4 v8, s[44:47], s51 offen nt lds
    s_add_u32 s51, s51, 65536
    s_load_dword s11, s[34:35], 0
    s_add_u32 s36, s18, s48
    s_addc_u32 s37, s19, 0
    s_add_u32 s40, s20, s48
    s_addc_u32 s41, s21, 0
    s_lshr_b32 s49, s22, 7
    s_add_u32 s49, s49, s8
    s_and_b32 s49, s49, 7
    s_cmp_eq_u32 s49, 3
    s_cselect_b64 vcc, -1, 0
    s_add_u32 m0, s59, 1024
    s_nop 0
    buffer_load_dwordx4 v8, s[44:47], s51 offen nt lds
    s_add_u32 s51, s51, 65536
    s_add_u32 m0, s59, 2048
    s_nop 0
    buffer_load_dwordx4 v8, s[44:47], s51 offen nt lds
    s_add_u32 s51, s51, 65536
    s_add_u32 m0, s59, 3072
    s_nop 0
    buffer_load_dwordx4 v8, s[44:47], s51 offen nt lds
    s_add_u32 s51, s51, 65536
    s_mov_b32 s44, s28
    s_mov_b32 s45, s29
    s_cmp_ge_u32 s10, 28
    s_cselect_b32 s46, 0, 1835008
    s_mov_b32 s51, s54
    s_add_u32 m0, s98, 16384
    s_nop 0
    buffer_load_dwordx4 v9, s[44:47], s51 offen nt lds
    s_add_u32 s51, s51, 28672
    s_add_u32 m0, s98, 17408
    s_nop 0
    buffer_load_dwordx4 v9, s[44:47], s51 offen nt lds
    s_add_u32 s51, s51, 28672
    s_barrier
    v_lshl_add_u32 v8, v13, 10, v14
    v_and_b32 v15, 3, v13
    v_lshl_add_u32 v10, v15, 17, v14
    v_lshrrev_b32 v13, 2, v13
    v_lshl_add_u32 v10, v13, 13, v10
    v_bfe_u32 v15, v1, 4, 1
    v_lshlrev_b32 v15, 5, v15
    v_xor_b32 v10, v15, v10
    s_lshl_b32 s99, s4, 9
    s_and_b32 s49, s3, 1
    s_lshl_b32 s49, s49, 6
    s_add_u32 s99, s99, s49
    s_lshl_b32 s49, s9, 1
    s_add_u32 s99, s99, s49
    s_lshr_b32 s49, s3, 1
    s_add_u32 s99, s99, s49
    s_lshl_b32 s99, s99, 10
    s_add_u32 s99, s99, s55
    s_lshl_b32 s49, s3, 2
    v_mov_b32 v12, s49
    s_lshl_b32 s49, s3, 9
    v_add_u32 v11, s49, v7
    v_lshlrev_b32 v15, 4, v5
    v_lshl_add_u32 v15, v3, 6, v15
    v_add_u32 v15, s49, v15
    s_lshl_b32 s49, s3, 11
    v_add_u32 v13, s49, v7
    s_mov_b32 s57, 0x05040100
    s_mov_b32 s58, 0x07060302
    s_lshl_b32 s48, s4, 2
    s_add_u32 s48, s48, s6
    s_lshl_b32 s48, s48, 3
    s_add_u32 s48, s48, s7
    s_lshl_b32 s48, s48, 11
    s_add_u32 s48, s48, 999424
    v_add_u32 v14, s48, v11
    v_mov_b32 v112, 0
    v_mov_b32 v113, 0
    v_mov_b32 v114, 0
    v_mov_b32 v115, 0
    v_mov_b32 v116, 0
    v_mov_b32 v117, 0
    v_mov_b32 v118, 0
    v_mov_b32 v119, 0
    v_mov_b32 v120, 0
    v_mov_b32 v121, 0
    v_mov_b32 v122, 0
    v_mov_b32 v123, 0
    v_mov_b32 v124, 0
    v_mov_b32 v125, 0
    v_mov_b32 v126, 0
    v_mov_b32 v127, 0
    v_mov_b32 v128, 0
    v_mov_b32 v129, 0
    v_mov_b32 v130, 0
    v_mov_b32 v131, 0
    v_mov_b32 v132, 0
    v_mov_b32 v133, 0
    v_mov_b32 v134, 0
    v_mov_b32 v135, 0
    v_mov_b32 v136, 0
    v_mov_b32 v137, 0
    v_mov_b32 v138, 0
    v_mov_b32 v139, 0
    v_mov_b32 v140, 0
    v_mov_b32 v141, 0
    v_mov_b32 v142, 0
    v_mov_b32 v143, 0
    s_add_u32 m0, s53, 65536
    s_waitcnt vmcnt(5)
    buffer_load_dwordx4 v6, s[36:39], s50 offen nt lds
    s_add_u32 s50, s50, 4096
    s_and_b32 s50, s50, 0xffff
    s_add_u32 m0, s53, 66560
    s_waitcnt vmcnt(5)
    buffer_load_dwordx4 v6, s[36:39], s50 offen nt lds
    s_add_u32 s50, s50, 4096
    s_and_b32 s50, s50, 0xffff
    s_mov_b32 s44, s30
    s_mov_b32 s45, s31
    s_lshl_b32 s51, s10, 16
    s_add_u32 s51, s51, s55
    s_add_u32 s51, s51, s53
    s_add_u32 m0, s98, 40960
    s_waitcnt vmcnt(5)
    buffer_load_dwordx4 v8, s[44:47], s51 offen nt lds
    s_add_u32 s51, s51, 8192
    s_add_u32 m0, s53, 67584
    s_waitcnt vmcnt(5)
    buffer_load_dwordx4 v6, s[36:39], s50 offen nt lds
    s_add_u32 s50, s50, 4096
    s_and_b32 s50, s50, 0xffff
    ds_write_b32 v12, v2 offset:62080
    s_add_u32 m0, s53, 68608
    s_waitcnt vmcnt(5)
    buffer_load_dwordx4 v6, s[36:39], s50 offen nt lds
    s_add_u32 s50, s50, 4096
    s_and_b32 s50, s50, 0xffff
    s_add_u32 m0, s98, 41984
    s_waitcnt vmcnt(5)
    buffer_load_dwordx4 v8, s[44:47], s51 offen nt lds
    s_add_u32 s51, s51, 8192
    ds_write_b32 v12, v2 offset:62176
    s_add_u32 m0, s53, 69632
    s_cbranch_vccnz L_dw12
    s_waitcnt vmcnt(5)
L_dw12:
    s_waitcnt vmcnt(6)
    buffer_load_dwordx4 v6, s[36:39], s50 offen nt lds
    s_add_u32 s50, s50, 4096
    s_and_b32 s50, s50, 0xffff
    s_add_u32 m0, s53, 70656
    s_cbranch_vccnz L_dw13
    s_waitcnt vmcnt(5)
L_dw13:
    s_waitcnt vmcnt(6)
    buffer_load_dwordx4 v6, s[36:39], s50 offen nt lds
    s_add_u32 s50, s50, 4096
    s_and_b32 s50, s50, 0xffff
    s_add_u32 m0, s53, 71680
    s_cbranch_vccnz L_dw14
    s_waitcnt vmcnt(5)
L_dw14:
    s_waitcnt vmcnt(6)
    buffer_load_dwordx4 v6, s[36:39], s50 offen nt lds
    s_add_u32 s50, s50, 4096
    s_and_b32 s50, s50, 0xffff
    s_add_u32 m0, s53, 72704
    s_cbranch_vccnz L_dw15
    s_waitcnt vmcnt(5)
L_dw15:
    s_waitcnt vmcnt(6)
    buffer_load_dwordx4 v6, s[36:39], s50 offen nt lds
    s_add_u32 s50, s50, 4096
    s_and_b32 s50, s50, 0xffff
    s_add_u32 m0, s53, 73728
    s_cbranch_vccnz L_dw16
    s_waitcnt vmcnt(5)
L_dw16:
    s_waitcnt vmcnt(6)
    buffer_load_dwordx4 v6, s[36:39], s50 offen nt lds
    s_add_u32 s50, s50, 4096
    s_and_b32 s50, s50, 0xffff
    s_add_u32 m0, s53, 74752
    s_cbranch_vccnz L_dw17
    s_waitcnt vmcnt(5)
L_dw17:
    s_waitcnt vmcnt(6)
    buffer_load_dwordx4 v6, s[36:39], s50 offen nt lds
    s_add_u32 s50, s50, 4096
    s_and_b32 s50, s50, 0xffff
    s_add_u32 m0, s53, 75776
    s_cbranch_vccnz L_dw18
    s_waitcnt vmcnt(5)
L_dw18:
    s_waitcnt vmcnt(6)
    buffer_load_dwordx4 v6, s[36:39], s50 offen nt lds
    s_add_u32 s50, s50, 4096
    s_and_b32 s50, s50, 0xffff
    s_add_u32 m0, s53, 76800
    s_cbranch_vccnz L_dw19
    s_waitcnt vmcnt(5)
L_dw19:
    s_waitcnt vmcnt(6)
    buffer_load_dwordx4 v6, s[36:39], s50 offen nt lds
    s_add_u32 s50, s50, 4096
    s_and_b32 s50, s50, 0xffff
    s_add_u32 m0, s53, 77824
    s_cbranch_vccnz L_dw20
    s_waitcnt vmcnt(5)
L_dw20:
    s_waitcnt vmcnt(6)
    buffer_load_dwordx4 v6, s[36:39], s50 offen nt lds
    s_add_u32 s50, s50, 4096
    s_and_b32 s50, s50, 0xffff
    s_add_u32 m0, s53, 78848
    s_cbranch_vccnz L_dw21
    s_waitcnt vmcnt(5)
L_dw21:
    s_waitcnt vmcnt(6)
    buffer_load_dwordx4 v6, s[36:39], s50 offen nt lds
    s_add_u32 s50, s50, 4096
    s_and_b32 s50, s50, 0xffff
    s_add_u32 m0, s53, 79872
    s_cbranch_vccnz L_dw22
    s_waitcnt vmcnt(5)
L_dw22:
    s_waitcnt vmcnt(6)
    buffer_load_dwordx4 v6, s[36:39], s50 offen nt lds
    s_add_u32 s50, s50, 4096
    s_and_b32 s50, s50, 0xffff
    s_add_u32 m0, s53, 80896
    s_cbranch_vccnz L_dw23
    s_waitcnt vmcnt(5)
L_dw23:
    s_waitcnt vmcnt(6)
    buffer_load_dwordx4 v6, s[36:39], s50 offen nt lds
    s_add_u32 s50, s50, 4096
    s_and_b32 s50, s50, 0xffff
    s_cbranch_vccnz L_dw24
    s_waitcnt vmcnt(5)
L_dw24:
    s_waitcnt vmcnt(6)
    buffer_load_dwordx4 v[16:19], v7, s[40:43], s50 offen nt
    s_add_u32 s50, s50, 4096
    s_and_b32 s50, s50, 0xffff
    s_cbranch_vccnz L_dw25
    s_waitcnt vmcnt(5)
L_dw25:
    s_waitcnt vmcnt(6)
    buffer_load_dwordx4 v[20:23], v7, s[40:43], s50 offen nt
    s_add_u32 s50, s50, 4096
    s_and_b32 s50, s50, 0xffff
    s_cbranch_vccnz L_dw26
    s_waitcnt vmcnt(5)
L_dw26:
    s_waitcnt vmcnt(6)
    buffer_load_dwordx4 v[24:27], v7, s[40:43], s50 offen nt
    s_add_u32 s50, s50, 4096
    s_and_b32 s50, s50, 0xffff
    s_cbranch_vccnz L_dw27
    s_waitcnt vmcnt(5)
L_dw27:
    s_waitcnt vmcnt(6)
    buffer_load_dwordx4 v[28:31], v7, s[40:43], s50 offen nt
    s_add_u32 s50, s50, 4096
    s_and_b32 s50, s50, 0xffff
    s_waitcnt vmcnt(5)
    buffer_load_dwordx4 v[32:35], v7, s[40:43], s50 offen nt
    s_add_u32 s50, s50, 4096
    s_and_b32 s50, s50, 0xffff
    s_waitcnt vmcnt(5)
    buffer_load_dwordx4 v[36:39], v7, s[40:43], s50 offen nt
    s_add_u32 s50, s50, 4096
    s_and_b32 s50, s50, 0xffff
    ds_write_b32 v12, v2 offset:62096
    s_waitcnt vmcnt(5)
    buffer_load_dwordx4 v[40:43], v7, s[40:43], s50 offen nt
    s_add_u32 s50, s50, 4096
    s_and_b32 s50, s50, 0xffff
    s_waitcnt vmcnt(5)
    buffer_load_dwordx4 v[44:47], v7, s[40:43], s50 offen nt
    s_add_u32 s50, s50, 4096
    s_and_b32 s50, s50, 0xffff
    v_perm_b32 v80, v20, v16, s57
    v_perm_b32 v84, v20, v16, s58
    v_perm_b32 v88, v21, v17, s57
    v_perm_b32 v92, v21, v17, s58
    v_perm_b32 v96, v22, v18, s57
    v_perm_b32 v100, v22, v18, s58
    v_perm_b32 v104, v23, v19, s57
    v_perm_b32 v108, v23, v19, s58
    s_waitcnt vmcnt(5)
    buffer_load_dwordx4 v[48:51], v7, s[40:43], s50 offen nt
    s_add_u32 s50, s50, 4096
    s_and_b32 s50, s50, 0xffff
    s_waitcnt vmcnt(5)
    buffer_load_dwordx4 v[52:55], v7, s[40:43], s50 offen nt
    s_add_u32 s50, s50, 4096
    s_and_b32 s50, s50, 0xffff
    v_perm_b32 v81, v28, v24, s57
    v_perm_b32 v85, v28, v24, s58
    v_perm_b32 v89, v29, v25, s57
    v_perm_b32 v93, v29, v25, s58
    v_perm_b32 v97, v30, v26, s57
    v_perm_b32 v101, v30, v26, s58
    v_perm_b32 v105, v31, v27, s57
    v_perm_b32 v109, v31, v27, s58
    s_waitcnt vmcnt(5)
    buffer_load_dwordx4 v[56:59], v7, s[40:43], s50 offen nt
    s_add_u32 s50, s50, 4096
    s_and_b32 s50, s50, 0xffff
    s_waitcnt vmcnt(5)
    buffer_load_dwordx4 v[60:63], v7, s[40:43], s50 offen nt
    s_add_u32 s50, s50, 4096
    s_and_b32 s50, s50, 0xffff
    v_perm_b32 v82, v36, v32, s57
    v_perm_b32 v86, v36, v32, s58
    v_perm_b32 v90, v37, v33, s57
    v_perm_b32 v94, v37, v33, s58
    v_perm_b32 v98, v38, v34, s57
    v_perm_b32 v102, v38, v34, s58
    v_perm_b32 v106, v39, v35, s57
    v_perm_b32 v110, v39, v35, s58
    s_waitcnt vmcnt(5)
    buffer_load_dwordx4 v[64:67], v7, s[40:43], s50 offen nt
    s_add_u32 s50, s50, 4096
    s_and_b32 s50, s50, 0xffff
    s_waitcnt vmcnt(5)
    buffer_load_dwordx4 v[68:71], v7, s[40:43], s50 offen nt
    s_add_u32 s50, s50, 4096
    s_and_b32 s50, s50, 0xffff
    v_perm_b32 v83, v44, v40, s57
    v_perm_b32 v87, v44, v40, s58
    v_perm_b32 v91, v45, v41, s57
    v_perm_b32 v95, v45, v41, s58
    v_perm_b32 v99, v46, v42, s57
    v_perm_b32 v103, v46, v42, s58
    v_perm_b32 v107, v47, v43, s57
    v_perm_b32 v111, v47, v43, s58
    s_waitcnt vmcnt(5)
    buffer_load_dwordx4 v[72:75], v7, s[40:43], s50 offen nt
    s_add_u32 s50, s50, 4096
    s_and_b32 s50, s50, 0xffff
    s_waitcnt vmcnt(5)
    buffer_load_dwordx4 v[76:79], v7, s[40:43], s50 offen nt
    s_add_u32 s50, s50, 4096
    s_and_b32 s50, s50, 0xffff
    v_perm_b32 v16, v52, v48, s57
    v_perm_b32 v20, v52, v48, s58
    v_perm_b32 v24, v53, v49, s57
    v_perm_b32 v28, v53, v49, s58
    v_perm_b32 v32, v54, v50, s57
    v_perm_b32 v36, v54, v50, s58
    v_perm_b32 v40, v55, v51, s57
    v_perm_b32 v44, v55, v51, s58
L_wp_c:
    ds_read_b32 v8, v12 offset:62128
    s_waitcnt lgkmcnt(0)
    v_cmp_eq_u32 vcc, 0, v8
    s_cbranch_vccnz L_wp
    s_mov_b32 exec_lo, 0xf000f
    s_mov_b32 exec_hi, 0xf000f
    ds_read_b128 v[112:115], v15 offset:62464
    ds_read_b128 v[128:131], v15 offset:62720
    s_mov_b32 exec_lo, 0xf000f0
    s_mov_b32 exec_hi, 0xf000f0
    ds_read_b128 v[116:119], v15 offset:62464
    ds_read_b128 v[132:135], v15 offset:62720
    s_mov_b32 exec_lo, 0xf000f00
    s_mov_b32 exec_hi, 0xf000f00
    ds_read_b128 v[120:123], v15 offset:62464
    ds_read_b128 v[136:139], v15 offset:62720
    s_mov_b32 exec_lo, 0xf000f000
    s_mov_b32 exec_hi, 0xf000f000
    ds_read_b128 v[124:127], v15 offset:62464
    ds_read_b128 v[140:143], v15 offset:62720
    s_mov_b64 exec, -1
    v_readfirstlane_b32 s52, v8
    s_lshr_b32 s52, s52, 1
    s_cmp_eq_u32 s8, s4
    s_cselect_b32 s53, s52, 0
    s_add_u32 s12, s11, 1
    s_add_u32 s13, s11, 0x156
    s_add_u32 s14, s11, 0x2ab
    s_add_u32 s15, s11, 0xc4
    s_and_b32 s12, s12, 1023
    s_and_b32 s13, s13, 1023
    s_and_b32 s14, s14, 1023
    s_and_b32 s15, s15, 1023
    s_waitcnt lgkmcnt(0)
    v_mfma_f32_16x16x32_bf16 v[144:147], v[112:115], v[80:83], 0
    v_mfma_f32_16x16x32_bf16 v[144:147], v[116:119], v[84:87], v[144:147]
    v_mfma_f32_16x16x32_bf16 v[144:147], v[120:123], v[88:91], v[144:147]
    v_mfma_f32_16x16x32_bf16 v[144:147], v[124:127], v[92:95], v[144:147]
    v_mfma_f32_16x16x32_bf16 v[148:151], v[112:115], v[96:99], 0
    v_mfma_f32_16x16x32_bf16 v[148:151], v[116:119], v[100:103], v[148:151]
    v_mfma_f32_16x16x32_bf16 v[148:151], v[120:123], v[104:107], v[148:151]
    v_mfma_f32_16x16x32_bf16 v[148:151], v[124:127], v[108:111], v[148:151]
    s_mov_b32 s44, s24
    s_mov_b32 s45, s25
    s_mov_b32 s46, 4194304
    s_mov_b32 s51, s99
    s_add_u32 m0, s59, 24576
    s_waitcnt vmcnt(5)
    buffer_load_dwordx4 v10, s[44:47], s51 offen nt lds
    s_add_u32 s51, s51, 16384
    v_xor_b32 v10, 64, v10
    s_add_u32 m0, s59, 25600
    s_waitcnt vmcnt(5)
    buffer_load_dwordx4 v10, s[44:47], s51 offen nt lds
    s_add_u32 s51, s51, 16384
    v_xor_b32 v10, 64, v10
    v_perm_b32 v17, v60, v56, s57
    v_perm_b32 v21, v60, v56, s58
    v_perm_b32 v25, v61, v57, s57
    v_perm_b32 v29, v61, v57, s58
    v_perm_b32 v33, v62, v58, s57
    v_perm_b32 v37, v62, v58, s58
    v_perm_b32 v41, v63, v59, s57
    v_perm_b32 v45, v63, v59, s58
    s_add_u32 m0, s59, 26624
    s_waitcnt vmcnt(5)
    buffer_load_dwordx4 v10, s[44:47], s51 offen nt lds
    s_add_u32 s51, s51, 16384
    v_xor_b32 v10, 64, v10
    s_add_u32 m0, s59, 27648
    s_waitcnt vmcnt(5)
    buffer_load_dwordx4 v10, s[44:47], s51 offen nt lds
    s_add_u32 s51, s51, 16384
    v_xor_b32 v10, 64, v10
    v_perm_b32 v18, v68, v64, s57
    v_perm_b32 v22, v68, v64, s58
    v_perm_b32 v26, v69, v65, s57
    v_perm_b32 v30, v69, v65, s58
    v_perm_b32 v34, v70, v66, s57
    v_perm_b32 v38, v70, v66, s58
    v_perm_b32 v42, v71, v67, s57
    v_perm_b32 v46, v71, v67, s58
    s_waitcnt vmcnt(4)
    v_perm_b32 v19, v76, v72, s57
    v_perm_b32 v23, v76, v72, s58
    v_perm_b32 v27, v77, v73, s57
    v_mfma_f32_16x16x32_bf16 v[144:147], v[128:131], v[16:19], v[144:147]
    v_perm_b32 v31, v77, v73, s58
    v_mfma_f32_16x16x32_bf16 v[144:147], v[132:135], v[20:23], v[144:147]
    v_perm_b32 v35, v78, v74, s57
    v_mfma_f32_16x16x32_bf16 v[144:147], v[136:139], v[24:27], v[144:147]
    v_perm_b32 v39, v78, v74, s58
    v_mfma_f32_16x16x32_bf16 v[144:147], v[140:143], v[28:31], v[144:147]
    v_perm_b32 v43, v79, v75, s57
    v_mfma_f32_16x16x32_bf16 v[148:151], v[128:131], v[32:35], v[148:151]
    v_perm_b32 v47, v79, v75, s58
    v_mfma_f32_16x16x32_bf16 v[148:151], v[132:135], v[36:39], v[148:151]
    v_mfma_f32_16x16x32_bf16 v[148:151], v[136:139], v[40:43], v[148:151]
    v_mfma_f32_16x16x32_bf16 v[148:151], v[140:143], v[44:47], v[148:151]
    s_nop 1
    ds_write_b128 v13, v[144:147] offset:49152
    s_cmp_eq_u32 s52, 0
    s_nop 3
    ds_write_b128 v13, v[148:151] offset:50176
    s_mov_b32 exec_hi, 0
    s_waitcnt lgkmcnt(0)
    s_barrier
    ds_read_b128 v[80:83], v11 offset:49152
    ds_read_b128 v[84:87], v11 offset:51200
    ds_read_b128 v[88:91], v11 offset:53248
    ds_read_b128 v[92:95], v11 offset:55296
    s_waitcnt lgkmcnt(2)
    v_pk_add_f32 v[80:81], v[80:81], v[84:85]
    v_pk_add_f32 v[82:83], v[82:83], v[86:87]
    s_waitcnt lgkmcnt(1)
    v_pk_add_f32 v[80:81], v[80:81], v[88:89]
    v_pk_add_f32 v[82:83], v[82:83], v[90:91]
    s_waitcnt lgkmcnt(0)
    v_pk_add_f32 v[80:81], v[80:81], v[92:93]
    v_pk_add_f32 v[82:83], v[82:83], v[94:95]
    v_bfi_b32 v80, v2, s12, v80
    v_bfi_b32 v81, v2, s13, v81
    v_bfi_b32 v82, v2, s14, v82
    v_bfi_b32 v83, v2, s15, v83
    s_cbranch_scc1 L_so_s
    global_store_dwordx4 v14, v[80:83], s[34:35]
L_so_e:
    s_mov_b32 exec_hi, -1
    s_setprio 0
    s_cmp_eq_u32 s3, 0
    s_cbranch_scc1 L_F
    s_waitcnt vmcnt(1)
    s_barrier
    s_barrier
    s_endpgm
L_F:
    s_waitcnt vmcnt(1)
    s_barrier
    v_lshrrev_b32 v157, 1, v1
    v_and_b32 v159, 1, v1
    v_lshlrev_b32 v157, 10, v157
    v_lshl_add_u32 v157, v159, 4, v157
    s_lshl_b32 s48, s4, 15
    s_lshl_b32 s49, s5, 5
    s_add_u32 s48, s48, s49
    s_add_u32 s48, s48, 1523712
    v_add_u32 v157, s48, v157
    v_add_u32 v158, 262144, v157
    v_lshlrev_b32 v159, 1, v159
    v_lshl_add_u32 v159, v3, 10, v159
    s_lshl_b32 s48, s4, 7
    s_lshl_b32 s49, s5, 2
    s_add_u32 s48, s48, s49
    v_add_u32 v159, s48, v159
    v_mov_b32 v152, 0
    v_mov_b32 v153, 0
    v_mov_b32 v154, 0
    v_mov_b32 v155, 0
    s_barrier
    global_load_ushort v156, v159, s[16:17]
    s_mov_b32 exec_hi, 0xffffff
    global_load_dwordx4 v[152:155], v158, s[34:35] sc1
    s_mov_b32 exec_hi, -1
    global_load_dwordx4 v[24:27], v157, s[34:35] sc1
    s_mov_b32 exec_hi, 0xffffff
    s_waitcnt vmcnt(0)
L_py_c:
    v_xor_b32 v152, s12, v152
    v_xor_b32 v153, s13, v153
    v_xor_b32 v154, s14, v154
    v_xor_b32 v155, s15, v155
    v_or3_b32 v6, v152, v153, v154
    v_bitop3_b32 v6, v155, v6, v2 bitop3:0xa8
    v_cmp_ne_u32 vcc, 0, v6
    s_and_b64 exec, exec, vcc
    s_cbranch_scc1 L_py
    s_mov_b64 exec, -1
    v_permlane32_swap_b32 v152, v154
    v_permlane32_swap_b32 v153, v155
    v_add_f32 v152, v152, v154
    v_add_f32 v153, v153, v155
    s_nop 1
    v_permlane16_swap_b32 v152, v153
    v_add_f32 v152, v152, v153
    s_nop 1
    v_add_f32_dpp v152, v152, v152 row_ror:8 row_mask:0xf bank_mask:0xf
    s_nop 1
    v_add_f32_dpp v152, v152, v152 row_ror:4 row_mask:0xf bank_mask:0xf
    s_nop 1
    v_add_f32_dpp v152, v152, v152 row_ror:2 row_mask:0xf bank_mask:0xf
    v_cvt_pk_bf16_f32 v152, 0, v152
    v_mul_f32 v17, 0xbfb8aa3b, v152
    v_exp_f32 v17, v17
    v_lshlrev_b32 v11, 16, v156
    v_add_f32 v17, 1.0, v17
    v_rcp_f32 v17, v17
    s_add_u32 s11, s11, 1
    v_mul_f32 v16, v152, v17
    v_cvt_pk_bf16_f32 v16, 0, v16
    s_setprio 3
    v_xor_b32 v20, s12, v24
    v_xor_b32 v21, s13, v25
    v_xor_b32 v22, s14, v26
    v_xor_b32 v23, s15, v27
    v_or3_b32 v6, v20, v21, v22
    v_bitop3_b32 v6, v23, v6, v2 bitop3:0xa8
    v_cmp_ne_u32 vcc, 0, v6
    s_and_b64 exec, exec, vcc
    s_cbranch_scc0 L_psd
    global_load_dwordx4 v[24:27], v157, s[34:35] sc1
    global_load_dwordx4 v[28:31], v157, s[34:35] sc1
L_ps:
    s_waitcnt vmcnt(1)
    v_xor_b32 v20, s12, v24
    v_xor_b32 v21, s13, v25
    v_xor_b32 v22, s14, v26
    v_xor_b32 v23, s15, v27
    v_or3_b32 v6, v20, v21, v22
    v_bitop3_b32 v6, v23, v6, v2 bitop3:0xa8
    v_cmp_ne_u32 vcc, 0, v6
    s_and_b64 exec, exec, vcc
    s_cbranch_scc0 L_psd
    global_load_dwordx4 v[24:27], v157, s[34:35] sc1
    s_sleep 1
    s_waitcnt vmcnt(1)
    v_xor_b32 v20, s12, v28
    v_xor_b32 v21, s13, v29
    v_xor_b32 v22, s14, v30
    v_xor_b32 v23, s15, v31
    v_or3_b32 v6, v20, v21, v22
    v_bitop3_b32 v6, v23, v6, v2 bitop3:0xa8
    v_cmp_ne_u32 vcc, 0, v6
    s_and_b64 exec, exec, vcc
    s_cbranch_scc0 L_psd
    global_load_dwordx4 v[28:31], v157, s[34:35] sc1
    s_sleep 1
    s_sub_u32 s56, s56, 1
    s_cbranch_scc0 L_ps
    s_endpgm
L_psd:
    s_mov_b64 exec, -1
    v_permlane32_swap_b32 v20, v22
    v_permlane32_swap_b32 v21, v23
    v_add_f32 v20, v20, v22
    v_add_f32 v21, v21, v23
    s_nop 1
    v_permlane16_swap_b32 v20, v21
    v_add_f32 v20, v20, v21
    s_nop 1
    v_add_f32_dpp v20, v20, v20 row_ror:8 row_mask:0xf bank_mask:0xf
    s_nop 1
    v_add_f32_dpp v20, v20, v20 row_ror:4 row_mask:0xf bank_mask:0xf
    s_nop 1
    v_add_f32_dpp v20, v20, v20 row_ror:2 row_mask:0xf bank_mask:0xf
    v_cvt_pk_bf16_f32 v20, 0, v20
    v_mul_f32 v20, v20, v16
    s_mov_b32 exec_lo, 0x00030003
    v_cvt_pk_bf16_f32 v20, 0, v20
    s_mov_b32 exec_hi, 0x00030003
    v_add_f32 v20, v20, v11
    s_cmp_lg_u32 s2, 0
    v_cvt_pk_bf16_f32 v20, v20, v20
    global_store_short v159, v20, s[32:33]
    s_cbranch_scc1 L_end
    s_mov_b64 exec, 1
    v_mov_b32 v8, 0
    v_mov_b32 v10, s11
    global_store_dword v8, v10, s[34:35]
    s_endpgm
L_HB:
    s_setprio 3
    s_cmp_lg_u32 s3, 0
    s_cbranch_scc1 L_H1
    v_lshrrev_b32 v3, 4, v1
    v_and_b32 v4, 15, v1
    v_lshlrev_b32 v4, 4, v4
    v_lshl_add_u32 v3, v3, 10, v4
    s_mov_b32 s48, s9
    s_add_u32 s49, s48, 0
    s_and_b32 s49, s49, 3
    s_lshl_b32 s49, s49, 8
    v_add_u32 v4, s49, v3
    s_add_u32 s49, s48, 1
    s_and_b32 s49, s49, 3
    s_lshl_b32 s49, s49, 8
    v_add_u32 v5, s49, v3
    s_add_u32 s49, s48, 2
    s_and_b32 s49, s49, 3
    s_lshl_b32 s49, s49, 8
    v_add_u32 v6, s49, v3
    s_add_u32 s49, s48, 3
    s_and_b32 s49, s49, 3
    s_lshl_b32 s49, s49, 8
    v_add_u32 v7, s49, v3
    s_waitcnt lgkmcnt(0)
    global_load_dwordx4 v[16:19], v4, s[16:17]
    global_load_dwordx4 v[20:23], v5, s[16:17]
    global_load_dwordx4 v[24:27], v6, s[16:17]
    global_load_dwordx4 v[28:31], v7, s[16:17]
    s_barrier
    s_load_dword s11, s[34:35], 0
    v_lshrrev_b32 v3, 4, v1
    v_bfe_u32 v4, v1, 2, 2
    v_and_b32 v5, 3, v1
    v_lshlrev_b32 v7, 4, v1
    v_lshl_add_u32 v10, v3, 3, v4
    v_lshlrev_b32 v10, 7, v10
    v_lshl_add_u32 v10, v5, 5, v10
    v_lshlrev_b32 v11, 4, v3
    v_lshl_add_u32 v11, v4, 8, v11
    v_lshlrev_b32 v12, 6, v3
    v_lshl_add_u32 v12, v5, 4, v12
    v_lshl_add_u32 v12, v4, 13, v12
    v_mov_b32 v9, 0
    s_mov_b32 s52, 0xaaaaaaaa
    s_mov_b32 s53, 0xaaaaaaaa
    s_mov_b32 s54, 0xcccccccc
    s_mov_b32 s55, 0xcccccccc
    s_mov_b32 s59, 0x3f803f80
    s_getreg_b32 s58, hwreg(HW_REG_XCC_ID)
    s_and_b32 s58, s58, 15
    s_lshl_b32 s58, s58, 6
    s_lshl_b32 s49, s4, 15
    s_lshl_b32 s50, s9, 11
    s_add_u32 s50, s50, s49
    s_lshl_b32 s51, s8, 8
    s_add_u32 s50, s50, s51
    s_add_u32 s50, s50, 16384
    s_lshl_b32 s51, s6, 13
    s_add_u32 s49, s49, s51
    s_add_u32 s49, s49, 20480
    v_add_u32 v12, s50, v12
    v_add_u32 v13, s49, v7
    s_waitcnt vmcnt(0)
    v_dot2_f32_bf16 v48, v16, s59, 0
    v_dot2_f32_bf16 v49, v16, v16, 0
    v_dot2_f32_bf16 v48, v17, s59, v48
    v_dot2_f32_bf16 v49, v17, v17, v49
    v_dot2_f32_bf16 v48, v18, s59, v48
    v_dot2_f32_bf16 v49, v18, v18, v49
    v_dot2_f32_bf16 v48, v19, s59, v48
    v_dot2_f32_bf16 v49, v19, v19, v49
    v_dot2_f32_bf16 v48, v20, s59, v48
    v_dot2_f32_bf16 v49, v20, v20, v49
    v_dot2_f32_bf16 v48, v21, s59, v48
    v_dot2_f32_bf16 v49, v21, v21, v49
    v_dot2_f32_bf16 v48, v22, s59, v48
    v_dot2_f32_bf16 v49, v22, v22, v49
    v_dot2_f32_bf16 v48, v23, s59, v48
    v_dot2_f32_bf16 v49, v23, v23, v49
    v_dot2_f32_bf16 v48, v24, s59, v48
    v_dot2_f32_bf16 v49, v24, v24, v49
    v_dot2_f32_bf16 v48, v25, s59, v48
    v_dot2_f32_bf16 v49, v25, v25, v49
    v_dot2_f32_bf16 v48, v26, s59, v48
    v_dot2_f32_bf16 v49, v26, v26, v49
    v_dot2_f32_bf16 v48, v27, s59, v48
    v_dot2_f32_bf16 v49, v27, v27, v49
    v_dot2_f32_bf16 v48, v28, s59, v48
    v_dot2_f32_bf16 v49, v28, v28, v49
    v_dot2_f32_bf16 v48, v29, s59, v48
    v_dot2_f32_bf16 v49, v29, v29, v49
    v_dot2_f32_bf16 v48, v30, s59, v48
    v_dot2_f32_bf16 v49, v30, v30, v49
    v_dot2_f32_bf16 v48, v31, s59, v48
    v_dot2_f32_bf16 v49, v31, v31, v49
    s_nop 1
    v_add_f32_dpp v48, v48, v48 row_ror:8 row_mask:0xf bank_mask:0xf
    v_add_f32_dpp v49, v49, v49 row_ror:8 row_mask:0xf bank_mask:0xf
    s_nop 0
    v_add_f32_dpp v48, v48, v48 row_ror:4 row_mask:0xf bank_mask:0xf
    v_add_f32_dpp v49, v49, v49 row_ror:4 row_mask:0xf bank_mask:0xf
    s_nop 0
    v_add_f32_dpp v48, v48, v48 row_ror:2 row_mask:0xf bank_mask:0xf
    v_add_f32_dpp v49, v49, v49 row_ror:2 row_mask:0xf bank_mask:0xf
    s_nop 0
    v_add_f32_dpp v48, v48, v48 row_ror:1 row_mask:0xf bank_mask:0xf
    v_add_f32_dpp v49, v49, v49 row_ror:1 row_mask:0xf bank_mask:0xf
    v_mul_f32 v48, 0x3b000000, v48
    v_mul_f32 v49, 0x3b000000, v49
    v_fma_f32 v49, -v48, v48, v49
    v_max_f32 v49, 0, v49
    v_cvt_pk_bf16_f32 v49, 0, v49
    v_add_f32 v49, 0x3727c5ac, v49
    v_cvt_pk_bf16_f32 v49, 0, v49
    v_sqrt_f32 v49, v49
    v_cvt_pk_bf16_f32 v48, 0, v48
    v_cvt_pk_bf16_f32 v49, 0, v49
    v_rcp_f32 v49, v49
    v_lshlrev_b32 v50, 16, v16
    v_and_b32 v51, 0xffff0000, v16
    v_sub_f32 v50, v50, v48
    v_sub_f32 v51, v51, v48
    v_cvt_pk_bf16_f32 v50, 0, v50
    v_cvt_pk_bf16_f32 v51, 0, v51
    v_mul_f32 v50, v50, v49
    v_mul_f32 v51, v51, v49
    v_cvt_pk_bf16_f32 v16, v50, v51
    v_lshlrev_b32 v50, 16, v17
    v_and_b32 v51, 0xffff0000, v17
    v_sub_f32 v50, v50, v48
    v_sub_f32 v51, v51, v48
    v_cvt_pk_bf16_f32 v50, 0, v50
    v_cvt_pk_bf16_f32 v51, 0, v51
    v_mul_f32 v50, v50, v49
    v_mul_f32 v51, v51, v49
    v_cvt_pk_bf16_f32 v17, v50, v51
    v_lshlrev_b32 v50, 16, v18
    v_and_b32 v51, 0xffff0000, v18
    v_sub_f32 v50, v50, v48
    v_sub_f32 v51, v51, v48
    v_cvt_pk_bf16_f32 v50, 0, v50
    v_cvt_pk_bf16_f32 v51, 0, v51
    v_mul_f32 v50, v50, v49
    v_mul_f32 v51, v51, v49
    v_cvt_pk_bf16_f32 v18, v50, v51
    v_lshlrev_b32 v50, 16, v19
    v_and_b32 v51, 0xffff0000, v19
    v_sub_f32 v50, v50, v48
    v_sub_f32 v51, v51, v48
    v_cvt_pk_bf16_f32 v50, 0, v50
    v_cvt_pk_bf16_f32 v51, 0, v51
    v_mul_f32 v50, v50, v49
    v_mul_f32 v51, v51, v49
    v_cvt_pk_bf16_f32 v19, v50, v51
    ds_write_b128 v7, v[16:19] offset:57344
    ds_read_b128 v[32:35], v11 offset:57344
    ds_read_b128 v[36:39], v11 offset:57408
    ds_read_b128 v[40:43], v11 offset:57472
    ds_read_b128 v[44:47], v11 offset:57536
    s_waitcnt lgkmcnt(0)
    s_add_u32 s12, s11, 1
    s_add_u32 s13, s11, 0x156
    s_add_u32 s14, s11, 0x2ab
    s_add_u32 s15, s11, 0xc4
    s_and_b32 s12, s12, 1023
    s_and_b32 s13, s13, 1023
    s_and_b32 s14, s14, 1023
    s_and_b32 s15, s15, 1023
    v_xor_b32_e64 v116, s12, 1
    v_xor_b32_e64 v117, s13, 1
    v_xor_b32_e64 v118, s14, 1
    v_xor_b32_e64 v119, s15, 1
    global_store_dwordx4 v12, v[116:119], s[34:35]
L_pqw_c:
    ds_read_b128 v[20:23], v9 offset:62080
    s_waitcnt lgkmcnt(0)
    v_bitop3_b32 v20, v20, v21, v22 bitop3:0x80
    v_and_b32 v20, v20, v23
    v_cmp_eq_u32 vcc, 0, v20
    s_cbranch_vccnz L_pqw
    ds_read_b64_tr_b16 v[48:49], v10 offset:0
    ds_read_b64_tr_b16 v[50:51], v10 offset:512
    ds_read_b64_tr_b16 v[52:53], v10 offset:8
    ds_read_b64_tr_b16 v[54:55], v10 offset:520
    ds_read_b64_tr_b16 v[56:57], v10 offset:16
    ds_read_b64_tr_b16 v[58:59], v10 offset:528
    ds_read_b64_tr_b16 v[60:61], v10 offset:24
    ds_read_b64_tr_b16 v[62:63], v10 offset:536
    s_waitcnt lgkmcnt(6)
    ds_read_b64_tr_b16 v[64:65], v10 offset:4096
    ds_read_b64_tr_b16 v[66:67], v10 offset:4608
    v_mfma_f32_16x16x32_bf16 v[112:115], v[48:51], v[32:35], 0
    s_waitcnt lgkmcnt(6)
    ds_read_b64_tr_b16 v[68:69], v10 offset:4104
    ds_read_b64_tr_b16 v[70:71], v10 offset:4616
    v_mfma_f32_16x16x32_bf16 v[116:119], v[52:55], v[32:35], 0
    s_waitcnt lgkmcnt(6)
    ds_read_b64_tr_b16 v[72:73], v10 offset:4112
    ds_read_b64_tr_b16 v[74:75], v10 offset:4624
    v_mfma_f32_16x16x32_bf16 v[120:123], v[56:59], v[32:35], 0
    s_waitcnt lgkmcnt(6)
    ds_read_b64_tr_b16 v[76:77], v10 offset:4120
    ds_read_b64_tr_b16 v[78:79], v10 offset:4632
    v_mfma_f32_16x16x32_bf16 v[124:127], v[60:63], v[32:35], 0
    s_waitcnt lgkmcnt(6)
    ds_read_b64_tr_b16 v[80:81], v10 offset:8192
    ds_read_b64_tr_b16 v[82:83], v10 offset:8704
    v_mfma_f32_16x16x32_bf16 v[112:115], v[64:67], v[36:39], v[112:115]
    s_waitcnt lgkmcnt(6)
    ds_read_b64_tr_b16 v[84:85], v10 offset:8200
    ds_read_b64_tr_b16 v[86:87], v10 offset:8712
    v_mfma_f32_16x16x32_bf16 v[116:119], v[68:71], v[36:39], v[116:119]
    s_waitcnt lgkmcnt(6)
    ds_read_b64_tr_b16 v[88:89], v10 offset:8208
    ds_read_b64_tr_b16 v[90:91], v10 offset:8720
    v_mfma_f32_16x16x32_bf16 v[120:123], v[72:75], v[36:39], v[120:123]
    s_waitcnt lgkmcnt(6)
    ds_read_b64_tr_b16 v[92:93], v10 offset:8216
    ds_read_b64_tr_b16 v[94:95], v10 offset:8728
    v_mfma_f32_16x16x32_bf16 v[124:127], v[76:79], v[36:39], v[124:127]
    s_waitcnt lgkmcnt(6)
    ds_read_b64_tr_b16 v[96:97], v10 offset:12288
    ds_read_b64_tr_b16 v[98:99], v10 offset:12800
    v_mfma_f32_16x16x32_bf16 v[112:115], v[80:83], v[40:43], v[112:115]
    s_waitcnt lgkmcnt(6)
    ds_read_b64_tr_b16 v[100:101], v10 offset:12296
    ds_read_b64_tr_b16 v[102:103], v10 offset:12808
    v_mfma_f32_16x16x32_bf16 v[116:119], v[84:87], v[40:43], v[116:119]
    s_waitcnt lgkmcnt(6)
    ds_read_b64_tr_b16 v[104:105], v10 offset:12304
    ds_read_b64_tr_b16 v[106:107], v10 offset:12816
    v_mfma_f32_16x16x32_bf16 v[120:123], v[88:91], v[40:43], v[120:123]
    s_waitcnt lgkmcnt(6)
    ds_read_b64_tr_b16 v[108:109], v10 offset:12312
    ds_read_b64_tr_b16 v[110:111], v10 offset:12824
    v_mfma_f32_16x16x32_bf16 v[124:127], v[92:95], v[40:43], v[124:127]
    s_waitcnt lgkmcnt(6)
    v_mfma_f32_16x16x32_bf16 v[112:115], v[96:99], v[44:47], v[112:115]
    s_waitcnt lgkmcnt(4)
    v_mfma_f32_16x16x32_bf16 v[116:119], v[100:103], v[44:47], v[116:119]
    s_waitcnt lgkmcnt(2)
    v_mfma_f32_16x16x32_bf16 v[120:123], v[104:107], v[44:47], v[120:123]
    s_waitcnt lgkmcnt(0)
    v_mfma_f32_16x16x32_bf16 v[124:127], v[108:111], v[44:47], v[124:127]
    s_nop 3
    v_cndmask_b32 v112, v112, v116, s[52:53]
    v_cndmask_b32 v113, v113, v117, s[52:53]
    v_cndmask_b32 v114, v114, v118, s[52:53]
    v_cndmask_b32 v115, v115, v119, s[52:53]
    v_cndmask_b32 v120, v120, v124, s[52:53]
    v_cndmask_b32 v121, v121, v125, s[52:53]
    v_cndmask_b32 v122, v122, v126, s[52:53]
    v_cndmask_b32 v123, v123, v127, s[52:53]
    v_cndmask_b32 v112, v112, v120, s[54:55]
    v_cndmask_b32 v113, v113, v121, s[54:55]
    v_cndmask_b32 v114, v114, v122, s[54:55]
    v_cndmask_b32 v115, v115, v123, s[54:55]
    v_bfi_b32 v116, v2, s12, v112
    v_bfi_b32 v117, v2, s13, v113
    v_bfi_b32 v118, v2, s14, v114
    v_bfi_b32 v119, v2, s15, v115
    s_xor_b32 s12, s12, s58
    s_xor_b32 s13, s13, s58
    s_xor_b32 s14, s14, s58
    s_xor_b32 s15, s15, s58
    v_bfi_b32 v112, v2, s12, v112
    v_bfi_b32 v113, v2, s13, v113
    v_bfi_b32 v114, v2, s14, v114
    v_bfi_b32 v115, v2, s15, v115
    global_store_dwordx4 v12, v[112:115], s[34:35]
    v_add_u32 v12, 491520, v12
    global_store_dwordx4 v12, v[116:119], s[34:35] sc1
    s_waitcnt vmcnt(0)
    s_mov_b32 s57, 5
L_pq:
    global_load_dwordx4 v[16:19], v13, s[34:35] offset:-4096 sc1
    global_load_dwordx4 v[20:23], v13, s[34:35] offset:-3072 sc1
    global_load_dwordx4 v[24:27], v13, s[34:35] offset:-2048 sc1
    global_load_dwordx4 v[28:31], v13, s[34:35] offset:-1024 sc1
    global_load_dwordx4 v[32:35], v13, s[34:35] offset:0 sc1
    global_load_dwordx4 v[36:39], v13, s[34:35] offset:1024 sc1
    global_load_dwordx4 v[40:43], v13, s[34:35] offset:2048 sc1
    global_load_dwordx4 v[44:47], v13, s[34:35] offset:3072 sc1
    s_waitcnt vmcnt(0)
    v_xor_b32 v16, s12, v16
    v_xor_b32 v17, s13, v17
    v_xor_b32 v18, s14, v18
    v_xor_b32 v19, s15, v19
    v_xor_b32 v20, s12, v20
    v_xor_b32 v21, s13, v21
    v_xor_b32 v22, s14, v22
    v_xor_b32 v23, s15, v23
    v_xor_b32 v24, s12, v24
    v_xor_b32 v25, s13, v25
    v_xor_b32 v26, s14, v26
    v_xor_b32 v27, s15, v27
    v_xor_b32 v28, s12, v28
    v_xor_b32 v29, s13, v29
    v_xor_b32 v30, s14, v30
    v_xor_b32 v31, s15, v31
    v_xor_b32 v32, s12, v32
    v_xor_b32 v33, s13, v33
    v_xor_b32 v34, s14, v34
    v_xor_b32 v35, s15, v35
    v_xor_b32 v36, s12, v36
    v_xor_b32 v37, s13, v37
    v_xor_b32 v38, s14, v38
    v_xor_b32 v39, s15, v39
    v_xor_b32 v40, s12, v40
    v_xor_b32 v41, s13, v41
    v_xor_b32 v42, s14, v42
    v_xor_b32 v43, s15, v43
    v_xor_b32 v44, s12, v44
    v_xor_b32 v45, s13, v45
    v_xor_b32 v46, s14, v46
    v_xor_b32 v47, s15, v47
    v_or3_b32 v6, v16, v17, v18
    v_or3_b32 v6, v19, v20, v6
    v_or3_b32 v6, v21, v22, v6
    v_or3_b32 v6, v23, v24, v6
    v_or3_b32 v6, v25, v26, v6
    v_or3_b32 v6, v27, v28, v6
    v_or3_b32 v6, v29, v30, v6
    v_or3_b32 v6, v31, v32, v6
    v_or3_b32 v6, v33, v34, v6
    v_or3_b32 v6, v35, v36, v6
    v_or3_b32 v6, v37, v38, v6
    v_or3_b32 v6, v39, v40, v6
    v_or3_b32 v6, v41, v42, v6
    v_or3_b32 v6, v43, v44, v6
    v_or3_b32 v6, v45, v46, v6
    v_bitop3_b32 v6, v47, v6, v2 bitop3:0xa8
    v_cmp_ne_u32 vcc, 0, v6
    s_cbranch_vccnz L_pq_r
    v_lshlrev_b32 v14, 3, v1
    v_pk_add_f32 v[16:17], v[16:17], v[24:25]
    v_pk_add_f32 v[32:33], v[32:33], v[40:41]
    v_pk_add_f32 v[18:19], v[18:19], v[26:27]
    v_pk_add_f32 v[34:35], v[34:35], v[42:43]
    v_pk_add_f32 v[20:21], v[20:21], v[28:29]
    v_pk_add_f32 v[36:37], v[36:37], v[44:45]
    v_pk_add_f32 v[22:23], v[22:23], v[30:31]
    v_pk_add_f32 v[38:39], v[38:39], v[46:47]
    v_pk_add_f32 v[16:17], v[16:17], v[32:33]
    v_pk_add_f32 v[18:19], v[18:19], v[34:35]
    v_pk_add_f32 v[20:21], v[20:21], v[36:37]
    v_pk_add_f32 v[22:23], v[22:23], v[38:39]
    v_cvt_pk_bf16_f32 v16, v16, v17
    v_cvt_pk_bf16_f32 v17, v18, v19
    v_cvt_pk_bf16_f32 v18, v20, v21
    v_cvt_pk_bf16_f32 v19, v22, v23
    s_cmp_gt_i32 s57, 0
    s_cselect_b32 s48, 3, 1
    ds_write_b64 v14, v[16:17] offset:59392
    v_mov_b32 v6, s48
    ds_write_b64 v14, v[18:19] offset:59904
    ds_write_b32 v9, v6 offset:62144
    s_waitcnt lgkmcnt(0)
    s_barrier
    s_barrier
    s_barrier
    s_endpgm
L_H1:
    s_cmp_ge_u32 s10, 28
    s_cbranch_scc1 L_end
    v_lshrrev_b32 v3, 4, v1
    v_and_b32 v4, 15, v1
    v_lshlrev_b32 v4, 4, v4
    v_lshl_add_u32 v3, v3, 10, v4
    s_xor_b32 s48, s8, 0
    s_lshr_b32 s48, s48, 1
    s_add_u32 s49, s48, 0
    s_and_b32 s49, s49, 3
    s_lshl_b32 s49, s49, 8
    v_add_u32 v4, s49, v3
    s_add_u32 s49, s48, 1
    s_and_b32 s49, s49, 3
    s_lshl_b32 s49, s49, 8
    v_add_u32 v5, s49, v3
    s_add_u32 s49, s48, 2
    s_and_b32 s49, s49, 3
    s_lshl_b32 s49, s49, 8
    v_add_u32 v6, s49, v3
    s_add_u32 s49, s48, 3
    s_and_b32 s49, s49, 3
    s_lshl_b32 s49, s49, 8
    v_add_u32 v7, s49, v3
    s_waitcnt lgkmcnt(0)
    global_load_dwordx4 v[16:19], v4, s[16:17]
    global_load_dwordx4 v[20:23], v5, s[16:17]
    global_load_dwordx4 v[24:27], v6, s[16:17]
    global_load_dwordx4 v[28:31], v7, s[16:17]
    s_barrier
    s_load_dword s11, s[34:35], 0
    v_lshrrev_b32 v3, 4, v1
    v_bfe_u32 v4, v1, 2, 2
    v_and_b32 v5, 3, v1
    v_lshlrev_b32 v7, 4, v1
    v_lshl_add_u32 v10, v3, 3, v4
    v_lshlrev_b32 v10, 7, v10
    v_lshl_add_u32 v10, v5, 5, v10
    v_lshlrev_b32 v11, 4, v3
    v_lshl_add_u32 v11, v4, 8, v11
    v_lshlrev_b32 v12, 6, v3
    v_lshl_add_u32 v12, v5, 4, v12
    v_lshl_add_u32 v12, v4, 8, v12
    v_mov_b32 v9, 0
    s_mov_b32 s52, 0xaaaaaaaa
    s_mov_b32 s53, 0xaaaaaaaa
    s_mov_b32 s54, 0xcccccccc
    s_mov_b32 s55, 0xcccccccc
    s_mov_b32 s59, 0x3f803f80
    s_getreg_b32 s58, hwreg(HW_REG_XCC_ID)
    s_and_b32 s58, s58, 15
    s_lshl_b32 s58, s58, 6
    s_xor_b32 s49, s8, 0
    s_and_b32 s49, s49, 1
    s_lshl_b32 s49, s49, 7
    v_add_u32 v11, s49, v11
    s_lshl_b32 s49, s10, 13
    s_lshl_b32 s50, s8, 10
    s_add_u32 s50, s50, s49
    s_add_u32 s50, s50, 278528
    s_add_u32 s49, s49, 282624
    v_add_u32 v12, s50, v12
    v_add_u32 v13, s49, v7
    s_waitcnt vmcnt(0)
    v_dot2_f32_bf16 v48, v16, s59, 0
    v_dot2_f32_bf16 v49, v16, v16, 0
    v_dot2_f32_bf16 v48, v17, s59, v48
    v_dot2_f32_bf16 v49, v17, v17, v49
    v_dot2_f32_bf16 v48, v18, s59, v48
    v_dot2_f32_bf16 v49, v18, v18, v49
    v_dot2_f32_bf16 v48, v19, s59, v48
    v_dot2_f32_bf16 v49, v19, v19, v49
    v_dot2_f32_bf16 v48, v20, s59, v48
    v_dot2_f32_bf16 v49, v20, v20, v49
    v_dot2_f32_bf16 v48, v21, s59, v48
    v_dot2_f32_bf16 v49, v21, v21, v49
    v_dot2_f32_bf16 v48, v22, s59, v48
    v_dot2_f32_bf16 v49, v22, v22, v49
    v_dot2_f32_bf16 v48, v23, s59, v48
    v_dot2_f32_bf16 v49, v23, v23, v49
    v_dot2_f32_bf16 v48, v24, s59, v48
    v_dot2_f32_bf16 v49, v24, v24, v49
    v_dot2_f32_bf16 v48, v25, s59, v48
    v_dot2_f32_bf16 v49, v25, v25, v49
    v_dot2_f32_bf16 v48, v26, s59, v48
    v_dot2_f32_bf16 v49, v26, v26, v49
    v_dot2_f32_bf16 v48, v27, s59, v48
    v_dot2_f32_bf16 v49, v27, v27, v49
    v_dot2_f32_bf16 v48, v28, s59, v48
    v_dot2_f32_bf16 v49, v28, v28, v49
    v_dot2_f32_bf16 v48, v29, s59, v48
    v_dot2_f32_bf16 v49, v29, v29, v49
    v_dot2_f32_bf16 v48, v30, s59, v48
    v_dot2_f32_bf16 v49, v30, v30, v49
    v_dot2_f32_bf16 v48, v31, s59, v48
    v_dot2_f32_bf16 v49, v31, v31, v49
    s_nop 1
    v_add_f32_dpp v48, v48, v48 row_ror:8 row_mask:0xf bank_mask:0xf
    v_add_f32_dpp v49, v49, v49 row_ror:8 row_mask:0xf bank_mask:0xf
    s_nop 0
    v_add_f32_dpp v48, v48, v48 row_ror:4 row_mask:0xf bank_mask:0xf
    v_add_f32_dpp v49, v49, v49 row_ror:4 row_mask:0xf bank_mask:0xf
    s_nop 0
    v_add_f32_dpp v48, v48, v48 row_ror:2 row_mask:0xf bank_mask:0xf
    v_add_f32_dpp v49, v49, v49 row_ror:2 row_mask:0xf bank_mask:0xf
    s_nop 0
    v_add_f32_dpp v48, v48, v48 row_ror:1 row_mask:0xf bank_mask:0xf
    v_add_f32_dpp v49, v49, v49 row_ror:1 row_mask:0xf bank_mask:0xf
    v_mul_f32 v48, 0x3b000000, v48
    v_mul_f32 v49, 0x3b000000, v49
    v_fma_f32 v49, -v48, v48, v49
    v_max_f32 v49, 0, v49
    v_cvt_pk_bf16_f32 v49, 0, v49
    v_add_f32 v49, 0x3727c5ac, v49
    v_cvt_pk_bf16_f32 v49, 0, v49
    v_sqrt_f32 v49, v49
    v_cvt_pk_bf16_f32 v48, 0, v48
    v_cvt_pk_bf16_f32 v49, 0, v49
    v_rcp_f32 v49, v49
    v_lshlrev_b32 v50, 16, v16
    v_and_b32 v51, 0xffff0000, v16
    v_sub_f32 v50, v50, v48
    v_sub_f32 v51, v51, v48
    v_cvt_pk_bf16_f32 v50, 0, v50
    v_cvt_pk_bf16_f32 v51, 0, v51
    v_mul_f32 v50, v50, v49
    v_mul_f32 v51, v51, v49
    v_cvt_pk_bf16_f32 v16, v50, v51
    v_lshlrev_b32 v50, 16, v17
    v_and_b32 v51, 0xffff0000, v17
    v_sub_f32 v50, v50, v48
    v_sub_f32 v51, v51, v48
    v_cvt_pk_bf16_f32 v50, 0, v50
    v_cvt_pk_bf16_f32 v51, 0, v51
    v_mul_f32 v50, v50, v49
    v_mul_f32 v51, v51, v49
    v_cvt_pk_bf16_f32 v17, v50, v51
    v_lshlrev_b32 v50, 16, v18
    v_and_b32 v51, 0xffff0000, v18
    v_sub_f32 v50, v50, v48
    v_sub_f32 v51, v51, v48
    v_cvt_pk_bf16_f32 v50, 0, v50
    v_cvt_pk_bf16_f32 v51, 0, v51
    v_mul_f32 v50, v50, v49
    v_mul_f32 v51, v51, v49
    v_cvt_pk_bf16_f32 v18, v50, v51
    v_lshlrev_b32 v50, 16, v19
    v_and_b32 v51, 0xffff0000, v19
    v_sub_f32 v50, v50, v48
    v_sub_f32 v51, v51, v48
    v_cvt_pk_bf16_f32 v50, 0, v50
    v_cvt_pk_bf16_f32 v51, 0, v51
    v_mul_f32 v50, v50, v49
    v_mul_f32 v51, v51, v49
    v_cvt_pk_bf16_f32 v19, v50, v51
    ds_write_b128 v7, v[16:19] offset:58368
    ds_read_b128 v[32:35], v11 offset:58368
    ds_read_b128 v[36:39], v11 offset:58432
    s_waitcnt lgkmcnt(0)
    s_add_u32 s12, s11, 1
    s_add_u32 s13, s11, 0x156
    s_add_u32 s14, s11, 0x2ab
    s_add_u32 s15, s11, 0xc4
    s_and_b32 s12, s12, 1023
    s_and_b32 s13, s13, 1023
    s_and_b32 s14, s14, 1023
    s_and_b32 s15, s15, 1023
    v_xor_b32_e64 v116, s12, 1
    v_xor_b32_e64 v117, s13, 1
    v_xor_b32_e64 v118, s14, 1
    v_xor_b32_e64 v119, s15, 1
    global_store_dwordx4 v12, v[116:119], s[34:35]
L_phw_c:
    ds_read_b128 v[20:23], v9 offset:62176
    s_waitcnt lgkmcnt(0)
    v_bitop3_b32 v20, v20, v21, v22 bitop3:0x80
    v_and_b32 v20, v20, v23
    v_cmp_eq_u32 vcc, 0, v20
    s_cbranch_vccnz L_phw
    ds_read_b64_tr_b16 v[48:49], v10 offset:16384
    ds_read_b64_tr_b16 v[50:51], v10 offset:16896
    ds_read_b64_tr_b16 v[52:53], v10 offset:16392
    ds_read_b64_tr_b16 v[54:55], v10 offset:16904
    ds_read_b64_tr_b16 v[56:57], v10 offset:16400
    ds_read_b64_tr_b16 v[58:59], v10 offset:16912
    ds_read_b64_tr_b16 v[60:61], v10 offset:16408
    ds_read_b64_tr_b16 v[62:63], v10 offset:16920
    s_waitcnt lgkmcnt(6)
    ds_read_b64_tr_b16 v[64:65], v10 offset:20480
    ds_read_b64_tr_b16 v[66:67], v10 offset:20992
    v_mfma_f32_16x16x32_bf16 v[112:115], v[48:51], v[32:35], 0
    s_waitcnt lgkmcnt(6)
    ds_read_b64_tr_b16 v[68:69], v10 offset:20488
    ds_read_b64_tr_b16 v[70:71], v10 offset:21000
    v_mfma_f32_16x16x32_bf16 v[116:119], v[52:55], v[32:35], 0
    s_waitcnt lgkmcnt(6)
    ds_read_b64_tr_b16 v[72:73], v10 offset:20496
    ds_read_b64_tr_b16 v[74:75], v10 offset:21008
    v_mfma_f32_16x16x32_bf16 v[120:123], v[56:59], v[32:35], 0
    s_waitcnt lgkmcnt(6)
    ds_read_b64_tr_b16 v[76:77], v10 offset:20504
    ds_read_b64_tr_b16 v[78:79], v10 offset:21016
    v_mfma_f32_16x16x32_bf16 v[124:127], v[60:63], v[32:35], 0
    s_waitcnt lgkmcnt(6)
    v_mfma_f32_16x16x32_bf16 v[112:115], v[64:67], v[36:39], v[112:115]
    s_waitcnt lgkmcnt(4)
    v_mfma_f32_16x16x32_bf16 v[116:119], v[68:71], v[36:39], v[116:119]
    s_waitcnt lgkmcnt(2)
    v_mfma_f32_16x16x32_bf16 v[120:123], v[72:75], v[36:39], v[120:123]
    s_waitcnt lgkmcnt(0)
    v_mfma_f32_16x16x32_bf16 v[124:127], v[76:79], v[36:39], v[124:127]
    s_nop 3
    v_cndmask_b32 v112, v112, v116, s[52:53]
    v_cndmask_b32 v113, v113, v117, s[52:53]
    v_cndmask_b32 v114, v114, v118, s[52:53]
    v_cndmask_b32 v115, v115, v119, s[52:53]
    v_cndmask_b32 v120, v120, v124, s[52:53]
    v_cndmask_b32 v121, v121, v125, s[52:53]
    v_cndmask_b32 v122, v122, v126, s[52:53]
    v_cndmask_b32 v123, v123, v127, s[52:53]
    v_cndmask_b32 v112, v112, v120, s[54:55]
    v_cndmask_b32 v113, v113, v121, s[54:55]
    v_cndmask_b32 v114, v114, v122, s[54:55]
    v_cndmask_b32 v115, v115, v123, s[54:55]
    v_bfi_b32 v116, v2, s12, v112
    v_bfi_b32 v117, v2, s13, v113
    v_bfi_b32 v118, v2, s14, v114
    v_bfi_b32 v119, v2, s15, v115
    s_xor_b32 s12, s12, s58
    s_xor_b32 s13, s13, s58
    s_xor_b32 s14, s14, s58
    s_xor_b32 s15, s15, s58
    v_bfi_b32 v112, v2, s12, v112
    v_bfi_b32 v113, v2, s13, v113
    v_bfi_b32 v114, v2, s14, v114
    v_bfi_b32 v115, v2, s15, v115
    global_store_dwordx4 v12, v[112:115], s[34:35]
    v_add_u32 v12, 491520, v12
    global_store_dwordx4 v12, v[116:119], s[34:35] sc1
    s_waitcnt vmcnt(0)
L_phk_c:
    ds_read_b128 v[20:23], v9 offset:62096
    s_waitcnt lgkmcnt(0)
    v_bitop3_b32 v20, v20, v21, v22 bitop3:0x80
    v_and_b32 v20, v20, v23
    v_cmp_eq_u32 vcc, 0, v20
    s_cbranch_vccnz L_phk
    s_mov_b32 s57, 5
L_ph:
    global_load_dwordx4 v[16:19], v13, s[34:35] offset:-4096 sc1
    global_load_dwordx4 v[20:23], v13, s[34:35] offset:-3072 sc1
    global_load_dwordx4 v[24:27], v13, s[34:35] offset:-2048 sc1
    global_load_dwordx4 v[28:31], v13, s[34:35] offset:-1024 sc1
    global_load_dwordx4 v[32:35], v13, s[34:35] offset:0 sc1
    global_load_dwordx4 v[36:39], v13, s[34:35] offset:1024 sc1
    global_load_dwordx4 v[40:43], v13, s[34:35] offset:2048 sc1
    global_load_dwordx4 v[44:47], v13, s[34:35] offset:3072 sc1
    s_waitcnt vmcnt(0)
    v_xor_b32 v16, s12, v16
    v_xor_b32 v17, s13, v17
    v_xor_b32 v18, s14, v18
    v_xor_b32 v19, s15, v19
    v_xor_b32 v20, s12, v20
    v_xor_b32 v21, s13, v21
    v_xor_b32 v22, s14, v22
    v_xor_b32 v23, s15, v23
    v_xor_b32 v24, s12, v24
    v_xor_b32 v25, s13, v25
    v_xor_b32 v26, s14, v26
    v_xor_b32 v27, s15, v27
    v_xor_b32 v28, s12, v28
    v_xor_b32 v29, s13, v29
    v_xor_b32 v30, s14, v30
    v_xor_b32 v31, s15, v31
    v_xor_b32 v32, s12, v32
    v_xor_b32 v33, s13, v33
    v_xor_b32 v34, s14, v34
    v_xor_b32 v35, s15, v35
    v_xor_b32 v36, s12, v36
    v_xor_b32 v37, s13, v37
    v_xor_b32 v38, s14, v38
    v_xor_b32 v39, s15, v39
    v_xor_b32 v40, s12, v40
    v_xor_b32 v41, s13, v41
    v_xor_b32 v42, s14, v42
    v_xor_b32 v43, s15, v43
    v_xor_b32 v44, s12, v44
    v_xor_b32 v45, s13, v45
    v_xor_b32 v46, s14, v46
    v_xor_b32 v47, s15, v47
    v_or3_b32 v6, v16, v17, v18
    v_or3_b32 v6, v19, v20, v6
    v_or3_b32 v6, v21, v22, v6
    v_or3_b32 v6, v23, v24, v6
    v_or3_b32 v6, v25, v26, v6
    v_or3_b32 v6, v27, v28, v6
    v_or3_b32 v6, v29, v30, v6
    v_or3_b32 v6, v31, v32, v6
    v_or3_b32 v6, v33, v34, v6
    v_or3_b32 v6, v35, v36, v6
    v_or3_b32 v6, v37, v38, v6
    v_or3_b32 v6, v39, v40, v6
    v_or3_b32 v6, v41, v42, v6
    v_or3_b32 v6, v43, v44, v6
    v_or3_b32 v6, v45, v46, v6
    v_bitop3_b32 v6, v47, v6, v2 bitop3:0xa8
    v_cmp_ne_u32 vcc, 0, v6
    s_cbranch_vccnz L_ph_r
    v_lshlrev_b32 v14, 3, v1
    s_add_u32 s12, s11, 1
    s_add_u32 s13, s11, 0x156
    s_add_u32 s14, s11, 0x2ab
    s_add_u32 s15, s11, 0xc4
    s_and_b32 s12, s12, 1023
    s_and_b32 s13, s13, 1023
    s_and_b32 s14, s14, 1023
    s_and_b32 s15, s15, 1023
    v_pk_add_f32 v[16:17], v[16:17], v[32:33]
    v_pk_add_f32 v[18:19], v[18:19], v[34:35]
    v_pk_add_f32 v[20:21], v[20:21], v[36:37]
    v_pk_add_f32 v[22:23], v[22:23], v[38:39]
    v_pk_add_f32 v[24:25], v[24:25], v[40:41]
    v_pk_add_f32 v[26:27], v[26:27], v[42:43]
    v_pk_add_f32 v[28:29], v[28:29], v[44:45]
    v_pk_add_f32 v[30:31], v[30:31], v[46:47]
    v_pk_add_f32 v[16:17], v[16:17], v[24:25]
    v_pk_add_f32 v[18:19], v[18:19], v[26:27]
    v_pk_add_f32 v[20:21], v[20:21], v[28:29]
    v_pk_add_f32 v[22:23], v[22:23], v[30:31]
    v_pk_add_f32 v[16:17], v[16:17], v[20:21]
    v_pk_add_f32 v[18:19], v[18:19], v[22:23]
    v_max_f32 v16, 0, v16
    v_max_f32 v17, 0, v17
    v_max_f32 v18, 0, v18
    v_max_f32 v19, 0, v19
    v_cvt_pk_bf16_f32 v16, v16, v17
    v_cvt_pk_bf16_f32 v17, v18, v19
    ds_write_b64 v14, v[16:17] offset:60416
    v_lshlrev_b32 v11, 4, v3
    v_lshl_add_u32 v11, v5, 7, v11
    v_lshl_add_u32 v10, v3, 3, v4
    v_lshlrev_b32 v10, 7, v10
    v_lshl_add_u32 v10, v5, 3, v10
    s_lshl_b32 s48, s8, 15
    s_lshl_b32 s49, s10, 10
    s_add_u32 s48, s48, s49
    s_add_u32 s48, s48, 1785856
    v_add_u32 v12, s48, v7
    ds_read_b128 v[32:35], v11 offset:60416
    ds_read_b64_tr_b16 v[48:49], v10 offset:40960
    ds_read_b64_tr_b16 v[50:51], v10 offset:41472
    ds_read_b64_tr_b16 v[52:53], v10 offset:40992
    ds_read_b64_tr_b16 v[54:55], v10 offset:41504
    ds_read_b64_tr_b16 v[56:57], v10 offset:41024
    ds_read_b64_tr_b16 v[58:59], v10 offset:41536
    ds_read_b64_tr_b16 v[60:61], v10 offset:41056
    ds_read_b64_tr_b16 v[62:63], v10 offset:41568
    s_waitcnt lgkmcnt(0)
    v_mfma_f32_16x16x32_bf16 v[112:115], v[32:35], v[48:51], 0
    v_mfma_f32_16x16x32_bf16 v[116:119], v[32:35], v[52:55], 0
    v_mfma_f32_16x16x32_bf16 v[120:123], v[32:35], v[56:59], 0
    v_mfma_f32_16x16x32_bf16 v[124:127], v[32:35], v[60:63], 0
    ds_read_b128 v[36:39], v11 offset:60480
    ds_read_b64_tr_b16 v[64:65], v10 offset:45056
    ds_read_b64_tr_b16 v[66:67], v10 offset:45568
    ds_read_b64_tr_b16 v[68:69], v10 offset:45088
    ds_read_b64_tr_b16 v[70:71], v10 offset:45600
    ds_read_b64_tr_b16 v[72:73], v10 offset:45120
    ds_read_b64_tr_b16 v[74:75], v10 offset:45632
    ds_read_b64_tr_b16 v[76:77], v10 offset:45152
    ds_read_b64_tr_b16 v[78:79], v10 offset:45664
    s_waitcnt lgkmcnt(0)
    v_mfma_f32_16x16x32_bf16 v[112:115], v[36:39], v[64:67], v[112:115]
    v_mfma_f32_16x16x32_bf16 v[116:119], v[36:39], v[68:71], v[116:119]
    v_mfma_f32_16x16x32_bf16 v[120:123], v[36:39], v[72:75], v[120:123]
    v_mfma_f32_16x16x32_bf16 v[124:127], v[36:39], v[76:79], v[124:127]
    s_nop 5
    v_mov_b32_dpp v112, v116 quad_perm:[0,1,2,3] row_mask:2 bank_mask:0xf
    v_mov_b32_dpp v113, v117 quad_perm:[0,1,2,3] row_mask:2 bank_mask:0xf
    v_mov_b32_dpp v114, v118 quad_perm:[0,1,2,3] row_mask:2 bank_mask:0xf
    v_mov_b32_dpp v115, v119 quad_perm:[0,1,2,3] row_mask:2 bank_mask:0xf
    v_mov_b32_dpp v112, v120 quad_perm:[0,1,2,3] row_mask:4 bank_mask:0xf
    v_mov_b32_dpp v113, v121 quad_perm:[0,1,2,3] row_mask:4 bank_mask:0xf
    v_mov_b32_dpp v114, v122 quad_perm:[0,1,2,3] row_mask:4 bank_mask:0xf
    v_mov_b32_dpp v115, v123 quad_perm:[0,1,2,3] row_mask:4 bank_mask:0xf
    v_mov_b32_dpp v112, v124 quad_perm:[0,1,2,3] row_mask:8 bank_mask:0xf
    v_mov_b32_dpp v113, v125 quad_perm:[0,1,2,3] row_mask:8 bank_mask:0xf
    v_mov_b32_dpp v114, v126 quad_perm:[0,1,2,3] row_mask:8 bank_mask:0xf
    v_mov_b32_dpp v115, v127 quad_perm:[0,1,2,3] row_mask:8 bank_mask:0xf
    v_bfi_b32 v112, v2, s12, v112
    v_bfi_b32 v113, v2, s13, v113
    v_bfi_b32 v114, v2, s14, v114
    v_bfi_b32 v115, v2, s15, v115
    global_store_dwordx4 v12, v[112:115], s[34:35] sc1
    s_barrier
    s_barrier
    s_barrier
    s_endpgm
L_B:
    s_sub_u32 s3, s3, 2
    v_lshrrev_b32 v3, 4, v1
    v_bfe_u32 v4, v1, 2, 2
    v_and_b32 v5, 3, v1
    v_lshlrev_b32 v7, 4, v1
    s_load_dword s11, s[34:35], 0
    s_lshl_b32 s51, s4, 2
    s_add_u32 s51, s51, s6
    s_lshl_b32 s51, s51, 3
    s_add_u32 s51, s51, s7
    v_and_b32 v8, 1, v1
    v_lshlrev_b32 v8, 7, v8
    v_bfe_u32 v9, v1, 1, 2
    v_lshl_add_u32 v8, v9, 13, v8
    s_lshl_b32 s49, s4, 15
    s_lshl_b32 s50, s9, 11
    s_add_u32 s50, s50, s49
    s_lshl_b32 s49, s8, 8
    s_add_u32 s50, s50, s49
    s_add_u32 s50, s50, 16384
    v_add_u32 v8, s50, v8
    v_lshlrev_b32 v9, 7, v1
    s_lshl_b32 s49, s10, 13
    s_lshl_b32 s50, s8, 10
    s_add_u32 s50, s50, s49
    s_add_u32 s50, s50, 277504
    s_mov_b64 exec, 0xff00
    v_add_u32 v8, s50, v9
    s_lshl_b32 s50, s51, 11
    s_add_u32 s50, s50, 997376
    s_mov_b32 exec_lo, 0xffff0000
    v_add_u32 v8, s50, v9
    s_lshl_b32 s54, s8, 15
    s_lshl_b32 s49, s10, 10
    s_add_u32 s54, s54, s49
    s_add_u32 s54, s54, 1523712
    s_sub_u32 s50, s54, 4096
    s_mov_b32 exec_lo, 0
    s_mov_b32 exec_hi, -1
    v_add_u32 v8, s50, v9
    s_mov_b64 exec, -1
    s_lshl_b32 s51, s51, 5
    s_add_u32 s51, s51, 4096
    v_writelane_b32 v8, s51, 40
    s_cmp_lg_u32 s3, 0
    s_cbranch_scc1 L_nopre
    s_cmp_eq_u32 s8, s4
    s_cselect_b32 exec_hi, 0x1ff, 0
    s_or_b32 exec_hi, exec_hi, 0x100
    s_mov_b32 exec_hi, 0x100
    s_mov_b32 exec_lo, 0
    global_load_dword v80, v8, s[34:35] sc1
    s_mov_b64 exec, -1
L_nopre:
    s_mov_b32 s59, 0x3fb8aa3b
    v_lshl_add_u32 v8, v3, 3, v4
    v_lshlrev_b32 v8, 7, v8
    v_lshl_add_u32 v8, v5, 3, v8
    s_lshl_b32 s48, s3, 5
    v_add_u32 v8, s48, v8
    v_bfe_u32 v9, v1, 3, 2
    v_lshlrev_b32 v9, 5, v9
    v_xor_b32 v8, v9, v8
    v_lshlrev_b32 v9, 4, v3
    v_lshl_add_u32 v9, v5, 8, v9
    v_lshlrev_b32 v99, 3, v5
    v_add_u32 v10, 61952, v99
    v_add_u32 v11, s48, v10
    v_add_u32 v99, s51, v99
    s_lshl_b32 s48, s3, 14
    s_add_u32 s48, s48, 65536
    v_add_u32 v92, s48, v7
    v_lshlrev_b32 v93, 8, v5
    v_lshl_add_u32 v93, v3, 6, v93
    v_lshl_add_u32 v93, v4, 4, v93
    s_lshl_b32 s48, s3, 2
    v_mov_b32 v94, s48
    v_lshlrev_b32 v95, 4, v5
    v_lshl_add_u32 v95, v3, 6, v95
    v_lshl_add_u32 v95, v4, 2, v95
    s_lshl_b32 s48, s3, 9
    v_add_u32 v95, s48, v95
    v_lshrrev_b32 v16, 5, v1
    v_and_b32 v98, 15, v1
    v_lshlrev_b32 v98, 3, v98
    v_lshl_add_u32 v98, v16, 7, v98
    s_lshl_b32 s48, s4, 2
    s_add_u32 s48, s48, s3
    s_lshl_b32 s49, s48, 8
    s_add_u32 s49, s49, 4096
    v_add_u32 v98, s49, v98
    v_and_b32 v96, 31, v1
    v_lshlrev_b32 v6, 4, v96
    v_lshl_add_u32 v6, v16, 13, v6
    s_lshl_b32 s48, s48, 14
    s_lshl_b32 s49, s9, 9
    s_add_u32 s48, s48, s49
    s_add_u32 s48, s48, 1003520
    v_add_u32 v6, s48, v6
    v_lshlrev_b32 v96, 3, v96
    v_lshl_add_u32 v96, v16, 2, v96
    s_lshl_b32 s49, s3, 8
    v_add_u32 v96, s49, v96
    s_add_u32 s54, s54, s49
    v_add_u32 v97, s54, v7
    s_waitcnt vmcnt(0) lgkmcnt(0)
    s_add_u32 s12, s11, 1
    s_add_u32 s13, s11, 0x156
    s_add_u32 s14, s11, 0x2ab
    s_add_u32 s15, s11, 0xc4
    s_and_b32 s12, s12, 1023
    s_and_b32 s13, s13, 1023
    s_and_b32 s14, s14, 1023
    s_and_b32 s15, s15, 1023
    s_lshl_b32 s50, s13, 10
    s_or_b32 s50, s50, s12
    s_and_b32 s50, s50, 0xffff
L_wk_c:
    ds_read_b32 v80, v94 offset:62096
    s_waitcnt lgkmcnt(0)
    v_cmp_eq_u32 vcc, 0, v80
    s_cbranch_vccnz L_wk
    s_sub_u32 s48, s51, 4096
    s_lshl_b32 s48, s48, 6
    s_lshl_b32 s49, s3, 10
    s_add_u32 s48, s48, s49
    s_add_u32 s48, s48, 999424
    s_sub_u32 s49, s54, 512
    s_cmp_eq_u32 s3, 2
    s_cselect_b32 s48, s49, s48
    v_add_u32 v87, s48, v7
    s_cmp_eq_u32 s8, s4
    s_cselect_b32 s49, 3, 2
    s_cmp_ge_u32 s3, s49
    s_cbranch_scc1 L_nopw
    global_load_dword v104, v87, s[34:35] sc1
L_nopw:
    ds_read_b128 v[16:19], v92 offset:0
    ds_read_b128 v[20:23], v92 offset:1024
    ds_read_b128 v[24:27], v92 offset:2048
    ds_read_b128 v[28:31], v92 offset:3072
    ds_read_b128 v[32:35], v92 offset:4096
    ds_read_b128 v[36:39], v92 offset:5120
    ds_read_b128 v[40:43], v92 offset:6144
    ds_read_b128 v[44:47], v92 offset:7168
    ds_read_b128 v[48:51], v92 offset:8192
    ds_read_b128 v[52:55], v92 offset:9216
    ds_read_b128 v[56:59], v92 offset:10240
    ds_read_b128 v[60:63], v92 offset:11264
    s_waitcnt lgkmcnt(0)
    ds_read_b128 v[64:67], v92 offset:12288
    ds_read_b128 v[68:71], v92 offset:13312
    ds_read_b128 v[72:75], v92 offset:14336
    ds_read_b128 v[76:79], v92 offset:15360
L_wq_c:
    ds_read_b32 v91, v90 offset:62144
    s_waitcnt lgkmcnt(0)
    v_cmp_eq_u32 vcc, 0, v91
    s_cbranch_vccnz L_wq
    ds_read_b128 v[100:103], v93 offset:59392
    s_setprio 1
    v_readfirstlane_b32 s52, v91
    s_lshr_b32 s52, s52, 1
    s_cmp_eq_u32 s8, s4
    s_cselect_b32 s53, s52, 0
    s_waitcnt lgkmcnt(0)
    v_mfma_f32_16x16x32_bf16 v[12:15], v[16:19], v[100:103], 0
    v_mfma_f32_16x16x32_bf16 v[16:19], v[20:23], v[100:103], 0
    v_mfma_f32_16x16x32_bf16 v[20:23], v[24:27], v[100:103], 0
    v_mfma_f32_16x16x32_bf16 v[24:27], v[28:31], v[100:103], 0
    s_nop 4
    v_add_f32_dpp v12, v13, v12 row_ror:12 row_mask:0xf bank_mask:0xf
    v_add_f32_dpp v14, v15, v14 row_ror:12 row_mask:0xf bank_mask:0xf
    v_mfma_f32_16x16x32_bf16 v[28:31], v[32:35], v[100:103], 0
    v_add_f32_dpp v16, v17, v16 row_ror:12 row_mask:0xf bank_mask:0xf
    v_add_f32_dpp v18, v19, v18 row_ror:12 row_mask:0xf bank_mask:0xf
    v_add_f32_dpp v80, v14, v12 row_ror:8 row_mask:0xf bank_mask:1
    v_mfma_f32_16x16x32_bf16 v[32:35], v[36:39], v[100:103], 0
    v_add_f32_dpp v20, v20, v21 row_ror:4 row_mask:0xf bank_mask:0xf
    v_add_f32_dpp v22, v22, v23 row_ror:4 row_mask:0xf bank_mask:0xf
    v_add_f32_dpp v81, v18, v16 row_ror:8 row_mask:0xf bank_mask:1
    v_mfma_f32_16x16x32_bf16 v[36:39], v[40:43], v[100:103], 0
    v_add_f32_dpp v24, v24, v25 row_ror:4 row_mask:0xf bank_mask:0xf
    v_add_f32_dpp v26, v26, v27 row_ror:4 row_mask:0xf bank_mask:0xf
    v_add_f32_dpp v80, v22, v20 row_ror:8 row_mask:0xf bank_mask:2
    v_mfma_f32_16x16x32_bf16 v[40:43], v[44:47], v[100:103], 0
    v_add_f32_dpp v28, v29, v28 row_ror:12 row_mask:0xf bank_mask:0xf
    v_add_f32_dpp v30, v31, v30 row_ror:12 row_mask:0xf bank_mask:0xf
    v_add_f32_dpp v81, v26, v24 row_ror:8 row_mask:0xf bank_mask:2
    v_mfma_f32_16x16x32_bf16 v[44:47], v[48:51], v[100:103], 0
    v_add_f32_dpp v32, v33, v32 row_ror:12 row_mask:0xf bank_mask:0xf
    v_add_f32_dpp v34, v35, v34 row_ror:12 row_mask:0xf bank_mask:0xf
    v_add_f32_dpp v80, v28, v30 row_ror:8 row_mask:0xf bank_mask:4
    v_mfma_f32_16x16x32_bf16 v[48:51], v[52:55], v[100:103], 0
    v_add_f32_dpp v36, v36, v37 row_ror:4 row_mask:0xf bank_mask:0xf
    v_add_f32_dpp v38, v38, v39 row_ror:4 row_mask:0xf bank_mask:0xf
    v_add_f32_dpp v81, v32, v34 row_ror:8 row_mask:0xf bank_mask:4
    v_mfma_f32_16x16x32_bf16 v[52:55], v[56:59], v[100:103], 0
    v_add_f32_dpp v40, v40, v41 row_ror:4 row_mask:0xf bank_mask:0xf
    v_add_f32_dpp v42, v42, v43 row_ror:4 row_mask:0xf bank_mask:0xf
    v_add_f32_dpp v80, v36, v38 row_ror:8 row_mask:0xf bank_mask:8
    v_mfma_f32_16x16x32_bf16 v[56:59], v[60:63], v[100:103], 0
    v_add_f32_dpp v44, v45, v44 row_ror:12 row_mask:0xf bank_mask:0xf
    v_add_f32_dpp v46, v47, v46 row_ror:12 row_mask:0xf bank_mask:0xf
    v_add_f32_dpp v81, v40, v42 row_ror:8 row_mask:0xf bank_mask:8
    v_mfma_f32_16x16x32_bf16 v[60:63], v[64:67], v[100:103], 0
    v_add_f32_dpp v48, v49, v48 row_ror:12 row_mask:0xf bank_mask:0xf
    v_add_f32_dpp v50, v51, v50 row_ror:12 row_mask:0xf bank_mask:0xf
    v_add_f32_dpp v82, v46, v44 row_ror:8 row_mask:0xf bank_mask:1
    v_mfma_f32_16x16x32_bf16 v[64:67], v[68:71], v[100:103], 0
    v_add_f32_dpp v52, v52, v53 row_ror:4 row_mask:0xf bank_mask:0xf
    v_add_f32_dpp v54, v54, v55 row_ror:4 row_mask:0xf bank_mask:0xf
    v_add_f32_dpp v83, v50, v48 row_ror:8 row_mask:0xf bank_mask:1
    v_mfma_f32_16x16x32_bf16 v[68:71], v[72:75], v[100:103], 0
    v_add_f32_dpp v56, v56, v57 row_ror:4 row_mask:0xf bank_mask:0xf
    v_add_f32_dpp v58, v58, v59 row_ror:4 row_mask:0xf bank_mask:0xf
    v_add_f32_dpp v82, v54, v52 row_ror:8 row_mask:0xf bank_mask:2
    v_mfma_f32_16x16x32_bf16 v[72:75], v[76:79], v[100:103], 0
    v_add_f32_dpp v60, v61, v60 row_ror:12 row_mask:0xf bank_mask:0xf
    v_add_f32_dpp v62, v63, v62 row_ror:12 row_mask:0xf bank_mask:0xf
    v_add_f32_dpp v83, v58, v56 row_ror:8 row_mask:0xf bank_mask:2
    v_add_f32_dpp v64, v65, v64 row_ror:12 row_mask:0xf bank_mask:0xf
    v_add_f32_dpp v66, v67, v66 row_ror:12 row_mask:0xf bank_mask:0xf
    v_add_f32_dpp v82, v60, v62 row_ror:8 row_mask:0xf bank_mask:4
    v_add_f32_dpp v68, v68, v69 row_ror:4 row_mask:0xf bank_mask:0xf
    v_add_f32_dpp v70, v70, v71 row_ror:4 row_mask:0xf bank_mask:0xf
    v_add_f32_dpp v83, v64, v66 row_ror:8 row_mask:0xf bank_mask:4
    v_add_f32_dpp v72, v72, v73 row_ror:4 row_mask:0xf bank_mask:0xf
    v_add_f32_dpp v74, v74, v75 row_ror:4 row_mask:0xf bank_mask:0xf
    v_add_f32_dpp v82, v68, v70 row_ror:8 row_mask:0xf bank_mask:8
    s_nop 0
    v_add_f32_dpp v83, v72, v74 row_ror:8 row_mask:0xf bank_mask:8
    v_cvt_pk_bf16_f32 v80, 0, v80
    v_cvt_pk_bf16_f32 v81, 0, v81
    v_cvt_pk_bf16_f32 v82, 0, v82
    v_cvt_pk_bf16_f32 v83, 0, v83
    v_mul_f32 v80, 0x3db504f3, v80
    v_mul_f32 v81, 0x3db504f3, v81
    v_mul_f32 v82, 0x3db504f3, v82
    v_mul_f32 v83, 0x3db504f3, v83
    v_cvt_pk_bf16_f32 v80, 0, v80
    v_cvt_pk_bf16_f32 v81, 0, v81
    v_cvt_pk_bf16_f32 v82, 0, v82
    v_cvt_pk_bf16_f32 v83, 0, v83
    v_max3_f32 v84, v80, v81, v82
    v_max_f32 v84, v84, v83
    s_nop 1
    v_max_f32_dpp v84, v84, v84 row_ror:8 row_mask:0xf bank_mask:0xf
    s_nop 1
    v_max_f32_dpp v84, v84, v84 row_ror:4 row_mask:0xf bank_mask:0xf
    v_mov_b32 v86, v84
    s_nop 1
    v_permlane16_swap_b32 v84, v86
    v_max_f32 v84, v84, v86
    v_mov_b32 v86, v84
    s_nop 1
    v_permlane32_swap_b32 v84, v86
    v_max_f32 v84, v84, v86
    v_sub_f32 v80, v80, v84
    v_sub_f32 v81, v81, v84
    v_sub_f32 v82, v82, v84
    v_sub_f32 v83, v83, v84
    v_mul_f32 v80, s59, v80
    v_mul_f32 v81, s59, v81
    v_mul_f32 v82, s59, v82
    v_mul_f32 v83, s59, v83
    v_exp_f32 v80, v80
    v_exp_f32 v81, v81
    v_exp_f32 v82, v82
    v_exp_f32 v83, v83
    v_add_f32 v85, v80, v81
    v_add_f32 v86, v82, v83
    v_add_f32 v85, v85, v86
    s_nop 1
    v_add_f32_dpp v85, v85, v85 row_ror:8 row_mask:0xf bank_mask:0xf
    s_nop 1
    v_add_f32_dpp v85, v85, v85 row_ror:4 row_mask:0xf bank_mask:0xf
    v_mov_b32 v86, v85
    s_nop 1
    v_permlane16_swap_b32 v85, v86
    v_add_f32 v85, v85, v86
    v_mov_b32 v86, v85
    s_nop 1
    v_permlane32_swap_b32 v85, v86
    v_add_f32 v85, v85, v86
    ds_write_b64 v11, v[84:85]
    ds_write_b32 v94, v2 offset:62112
L_wm_c:
    ds_read_b128 v[12:15], v90 offset:62112
    s_waitcnt lgkmcnt(0)
    v_bitop3_b32 v12, v12, v13, v14 bitop3:0x80
    v_and_b32 v12, v12, v15
    v_cmp_eq_u32 vcc, 0, v12
    s_cbranch_vccnz L_wm
    ds_read2_b64 v[16:19], v10 offset0:0 offset1:4
    ds_read2_b64 v[20:23], v10 offset0:8 offset1:12
    s_waitcnt lgkmcnt(0)
    v_max3_f32 v24, v16, v18, v20
    v_max_f32 v24, v24, v22
    v_sub_f32 v84, v84, v24
    v_mul_f32 v84, s59, v84
    v_exp_f32 v84, v84
    s_nop 0
    v_mul_f32 v80, v84, v80
    v_mul_f32 v81, v84, v81
    v_mul_f32 v82, v84, v82
    v_mul_f32 v83, v84, v83
    v_cvt_pk_bf16_f32 v80, v80, v81
    v_cvt_pk_bf16_f32 v81, v82, v83
    ds_write_b32 v95, v80 offset:62464
    ds_write_b32 v95, v81 offset:62720
    ds_write_b32 v94, v91 offset:62128
    s_cmp_lg_u32 s3, 2
    s_cbranch_scc1 L_noml
    v_sub_f32 v16, v16, v24
    v_sub_f32 v18, v18, v24
    v_sub_f32 v20, v20, v24
    v_sub_f32 v22, v22, v24
    v_mul_f32 v16, s59, v16
    v_mul_f32 v18, s59, v18
    v_mul_f32 v20, s59, v20
    v_mul_f32 v22, s59, v22
    v_exp_f32 v16, v16
    v_exp_f32 v18, v18
    v_exp_f32 v20, v20
    v_exp_f32 v22, v22
    v_mul_f32 v25, v16, v17
    v_fmac_f32 v25, v18, v19
    v_fmac_f32 v25, v20, v21
    v_fmac_f32 v25, v22, v23
    v_or_b32 v24, s50, v24
    v_bfi_b32 v25, v2, s14, v25
    s_mov_b64 exec, 15
    s_cmp_eq_u32 s52, 0
    s_cbranch_scc1 L_sml_s
    global_store_dwordx2 v99, v[24:25], s[34:35]
L_sml_e:
    s_mov_b64 exec, -1
L_noml:
    v_mov_b32 v33, 0xffff
    s_waitcnt lgkmcnt(0)
    s_setprio 3
    s_barrier
    global_load_dwordx2 v[56:57], v98, s[34:35] sc1
    s_barrier
    global_load_dwordx4 v[64:67], v6, s[34:35] offset:-4096 sc1
    global_load_dwordx4 v[68:71], v6, s[34:35] offset:-2048 sc1
    global_load_dwordx4 v[72:75], v6, s[34:35] offset:0 sc1
    global_load_dwordx4 v[76:79], v6, s[34:35] offset:2048 sc1
    ds_read_b64_tr_b16 v[16:17], v8 offset:24576
    ds_read_b64_tr_b16 v[18:19], v8 offset:25088
    ds_read_b64_tr_b16 v[20:21], v8 offset:28672
    ds_read_b64_tr_b16 v[22:23], v8 offset:29184
    ds_read_b64_tr_b16 v[24:25], v8 offset:32768
    ds_read_b64_tr_b16 v[26:27], v8 offset:33280
    ds_read_b64_tr_b16 v[28:29], v8 offset:36864
    ds_read_b64_tr_b16 v[30:31], v8 offset:37376
L_pml:
    s_waitcnt vmcnt(4)
    v_xor_b32 v56, s50, v56
    v_xor_b32 v57, s14, v57
    v_and_b32 v32, v33, v56
    v_and_or_b32 v32, v57, v2, v32
    v_max_f32_dpp v58, v56, v56 row_ror:8 row_mask:0xf bank_mask:0xf
    v_cmp_ne_u32 vcc, 0, v32
    s_cbranch_vccnz L_pml_r
    v_max_f32_dpp v58, v58, v58 row_ror:4 row_mask:0xf bank_mask:0xf
    v_mov_b32 v59, v58
    s_nop 1
    v_permlane32_swap_b32 v58, v59
    v_max_f32 v58, v58, v59
    v_sub_f32 v56, v56, v58
    v_mul_f32 v56, s59, v56
    v_exp_f32 v56, v56
    s_nop 0
    v_mul_f32 v57, v56, v57
    s_nop 1
    v_add_f32_dpp v57, v57, v57 row_ror:8 row_mask:0xf bank_mask:0xf
    s_nop 1
    v_add_f32_dpp v57, v57, v57 row_ror:4 row_mask:0xf bank_mask:0xf
    v_mov_b32 v59, v57
    s_nop 1
    v_permlane32_swap_b32 v57, v59
    v_add_f32 v57, v57, v59
    v_rcp_f32 v57, v57
    s_nop 0
    v_mul_f32 v56, v56, v57
L_po_c:
    s_waitcnt vmcnt(3)
    v_xor_b32 v64, s12, v64
    v_xor_b32 v65, s13, v65
    v_xor_b32 v66, s14, v66
    v_xor_b32 v67, s15, v67
    v_or3_b32 v32, v64, v65, 0
    v_or3_b32 v32, v66, v67, v32
    v_mul_f32_dpp v60, v56, v64 row_newbcast:0 row_mask:0xf bank_mask:0xf
    v_mul_f32_dpp v61, v56, v65 row_newbcast:1 row_mask:0xf bank_mask:0xf
    v_mul_f32_dpp v62, v56, v66 row_newbcast:2 row_mask:0xf bank_mask:0xf
    v_mul_f32_dpp v63, v56, v67 row_newbcast:3 row_mask:0xf bank_mask:0xf
    s_waitcnt vmcnt(2)
    v_xor_b32 v68, s12, v68
    v_xor_b32 v69, s13, v69
    v_xor_b32 v70, s14, v70
    v_xor_b32 v71, s15, v71
    v_or3_b32 v32, v68, v69, v32
    v_or3_b32 v32, v70, v71, v32
    v_fmac_f32_dpp v60, v56, v68 row_newbcast:4 row_mask:0xf bank_mask:0xf
    v_fmac_f32_dpp v61, v56, v69 row_newbcast:5 row_mask:0xf bank_mask:0xf
    v_fmac_f32_dpp v62, v56, v70 row_newbcast:6 row_mask:0xf bank_mask:0xf
    v_fmac_f32_dpp v63, v56, v71 row_newbcast:7 row_mask:0xf bank_mask:0xf
    s_waitcnt vmcnt(1)
    v_xor_b32 v72, s12, v72
    v_xor_b32 v73, s13, v73
    v_xor_b32 v74, s14, v74
    v_xor_b32 v75, s15, v75
    v_or3_b32 v32, v72, v73, v32
    v_or3_b32 v32, v74, v75, v32
    v_fmac_f32_dpp v60, v56, v72 row_newbcast:8 row_mask:0xf bank_mask:0xf
    v_fmac_f32_dpp v61, v56, v73 row_newbcast:9 row_mask:0xf bank_mask:0xf
    v_fmac_f32_dpp v62, v56, v74 row_newbcast:10 row_mask:0xf bank_mask:0xf
    v_fmac_f32_dpp v63, v56, v75 row_newbcast:11 row_mask:0xf bank_mask:0xf
    s_waitcnt vmcnt(0)
    v_xor_b32 v76, s12, v76
    v_xor_b32 v77, s13, v77
    v_xor_b32 v78, s14, v78
    v_xor_b32 v79, s15, v79
    v_or3_b32 v32, v76, v77, v32
    v_or3_b32 v32, v78, v79, v32
    v_and_b32 v32, v2, v32
    v_cmp_ne_u32 vcc, 0, v32
    v_fmac_f32_dpp v60, v56, v76 row_newbcast:12 row_mask:0xf bank_mask:0xf
    v_fmac_f32_dpp v61, v56, v77 row_newbcast:13 row_mask:0xf bank_mask:0xf
    v_fmac_f32_dpp v62, v56, v78 row_newbcast:14 row_mask:0xf bank_mask:0xf
    v_fmac_f32_dpp v63, v56, v79 row_newbcast:15 row_mask:0xf bank_mask:0xf
    s_cbranch_vccnz L_po
    v_permlane32_swap_b32 v60, v62
    v_permlane32_swap_b32 v61, v63
    v_add_f32 v60, v60, v62
    v_add_f32 v61, v61, v63
    v_cvt_pk_bf16_f32 v60, v60, v61
    ds_write_b32 v96, v60 offset:60928
    s_waitcnt lgkmcnt(0)
    s_barrier
    ds_read_b128 v[64:67], v9 offset:60928
    ds_read_b128 v[68:71], v9 offset:60992
    ds_read_b128 v[72:75], v9 offset:61056
    ds_read_b128 v[76:79], v9 offset:61120
    s_waitcnt lgkmcnt(3)
    v_mfma_f32_16x16x32_bf16 v[48:51], v[64:67], v[16:19], 0
    s_waitcnt lgkmcnt(2)
    v_mfma_f32_16x16x32_bf16 v[48:51], v[68:71], v[20:23], v[48:51]
    s_waitcnt lgkmcnt(1)
    v_mfma_f32_16x16x32_bf16 v[48:51], v[72:75], v[24:27], v[48:51]
    s_waitcnt lgkmcnt(0)
    v_mfma_f32_16x16x32_bf16 v[48:51], v[76:79], v[28:31], v[48:51]
    s_mov_b64 exec, 0xffff
    s_cmp_eq_u32 s53, 0
    s_nop 5
    v_bfi_b32 v48, v2, s12, v48
    v_bfi_b32 v49, v2, s13, v49
    v_bfi_b32 v50, v2, s14, v50
    v_bfi_b32 v51, v2, s15, v51
    s_cbranch_scc0 L_ss_s
    global_store_dwordx4 v97, v[48:51], s[34:35] sc1
L_ss_e:
    s_endpgm
L_wp:
    s_sleep 1
    s_sub_u32 s56, s56, 1
    s_cbranch_scc0 L_wp_c
    s_endpgm
L_so_s:
    global_store_dwordx4 v14, v[80:83], s[34:35] sc1
    s_branch L_so_e
L_py:
    global_load_dwordx4 v[152:155], v158, s[34:35] sc1
    s_sub_u32 s56, s56, 1
    s_waitcnt vmcnt(0)
    s_cbranch_scc0 L_py_c
    s_endpgm
L_pqw:
    s_sleep 1
    s_sub_u32 s56, s56, 1
    s_cbranch_scc0 L_pqw_c
    s_endpgm
L_pq_r:
    s_sub_u32 s56, s56, 1
    s_cbranch_scc1 L_end
    s_sub_u32 s57, s57, 1
    s_cmp_lg_u32 s57, 0
    s_cbranch_scc1 L_pq
L_pq_sw:
    s_mov_b32 s57, 0
    v_add_u32 v13, 491520, v13
    s_xor_b32 s12, s12, s58
    s_xor_b32 s13, s13, s58
    s_xor_b32 s14, s14, s58
    s_xor_b32 s15, s15, s58
    s_branch L_pq
L_phw:
    s_sleep 1
    s_sub_u32 s56, s56, 1
    s_cbranch_scc0 L_phw_c
    s_endpgm
L_phk:
    s_sleep 1
    s_sub_u32 s56, s56, 1
    s_cbranch_scc0 L_phk_c
    s_endpgm
L_ph_r:
    s_sub_u32 s56, s56, 1
    s_cbranch_scc1 L_end
    s_sub_u32 s57, s57, 1
    s_cmp_lg_u32 s57, 0
    s_cbranch_scc1 L_ph
L_ph_sw:
    s_mov_b32 s57, 0
    v_add_u32 v13, 491520, v13
    s_xor_b32 s12, s12, s58
    s_xor_b32 s13, s13, s58
    s_xor_b32 s14, s14, s58
    s_xor_b32 s15, s15, s58
    s_branch L_ph
L_wk:
    s_sleep 1
    s_sub_u32 s56, s56, 1
    s_cbranch_scc0 L_wk_c
    s_endpgm
L_wq:
    s_sleep 1
    s_sub_u32 s56, s56, 1
    s_cbranch_scc0 L_wq_c
    s_endpgm
L_wm:
    s_sleep 1
    s_sub_u32 s56, s56, 1
    s_cbranch_scc0 L_wm_c
    s_endpgm
L_sml_s:
    global_store_dwordx2 v99, v[24:25], s[34:35] sc1
    s_branch L_sml_e
L_pml_r:
    global_load_dwordx2 v[56:57], v98, s[34:35] sc1
    global_load_dwordx4 v[64:67], v6, s[34:35] offset:-4096 sc1
    global_load_dwordx4 v[68:71], v6, s[34:35] offset:-2048 sc1
    global_load_dwordx4 v[72:75], v6, s[34:35] offset:0 sc1
    global_load_dwordx4 v[76:79], v6, s[34:35] offset:2048 sc1
    s_sub_u32 s56, s56, 1
    s_cbranch_scc0 L_pml
    s_endpgm
L_po:
    global_load_dwordx4 v[64:67], v6, s[34:35] offset:-4096 sc1
    global_load_dwordx4 v[68:71], v6, s[34:35] offset:-2048 sc1
    global_load_dwordx4 v[72:75], v6, s[34:35] offset:0 sc1
    global_load_dwordx4 v[76:79], v6, s[34:35] offset:2048 sc1
    s_sub_u32 s56, s56, 1
    s_cbranch_scc0 L_po_c
    s_endpgm
L_ss_s:
    global_store_dwordx4 v97, v[48:51], s[34:35]
    s_branch L_ss_e
L_end:
    s_endpgm
.section .rodata,"a"
.p2align 6
.amdhsa_kernel recurrent_scan__sliding_block_cached__dense_activation_relu__decode_kernel
  .amdhsa_next_free_vgpr 160
  .amdhsa_next_free_sgpr 100
  .amdhsa_accum_offset 160
  .amdhsa_group_segment_fixed_size 0
  .amdhsa_kernarg_size 88
  .amdhsa_user_sgpr_count 2
  .amdhsa_user_sgpr_kernarg_segment_ptr 1
  .amdhsa_system_sgpr_workgroup_id_x 1
  .amdhsa_float_denorm_mode_32 3
.end_amdhsa_kernel
```
